```python
import torch

def _softmax(x, axis=-1):
    return torch.softmax(x, dim=axis)
def _gelu(x):
    return torch.nn.functional.gelu(x, approximate="tanh")
def _silu(x):
    return torch.nn.functional.silu(x)
def _sigmoid(x):
    return torch.sigmoid(x)
def _layernorm(x, axis=-1, eps=1e-5):
    m = x.mean(dim=axis, keepdim=True)
    v = x.var(dim=axis, keepdim=True, unbiased=False)
    return (x - m) / torch.sqrt(v + eps)
def _scatter_add(tgt, idx, src, axis=0):
    return tgt.clone().index_add_(axis, idx, src)
def _segment_sum(src, seg, n):
    out = torch.zeros((n,) + src.shape[1:], dtype=src.dtype)
    return out.index_add_(0, seg, src)
def _pad(x, pw):
    flat = tuple(v for pair in reversed(pw) for v in pair)
    return torch.nn.functional.pad(x, flat)

kernel_name = 'gather_scatter__edge_featured_mpnn_gatedgcn__graph'

def setup_inputs():

    _w = (lambda a: (lambda t: t.to(torch.bfloat16) if t.is_floating_point() else t)(torch.as_tensor(a)))
    N, deg, D, De = 10000, 16, 128, max(16, 1)
    E = N * deg
    return {
        "x": _w((lambda *s: torch.randn(*s, dtype=torch.bfloat16) * 0.4)(N, D)),
        "e_attr": _w((lambda *s: torch.randn(*s, dtype=torch.bfloat16) * 0.4)(E, De)),
        "src": _w((lambda lo, hi, *s: torch.randint(lo, hi, s))(0, N, E).to(torch.int64)),
        "dst": _w((lambda lo, hi, *s: torch.randint(lo, hi, s))(0, N, E).to(torch.int64)),
        "w_a": _w((lambda *s: torch.randn(*s, dtype=torch.bfloat16) * 0.4)(D, D)),
        "w_b": _w((lambda *s: torch.randn(*s, dtype=torch.bfloat16) * 0.4)(D, D)),
        "w_c": _w((lambda *s: torch.randn(*s, dtype=torch.bfloat16) * 0.4)(De, D)),
        "w_u": _w((lambda *s: torch.randn(*s, dtype=torch.bfloat16) * 0.05)(D, D)),
        "w_v": _w((lambda *s: torch.randn(*s, dtype=torch.bfloat16) * 0.05)(D, D)),
    }

def reference(x, e_attr, src, dst, w_a, w_b, w_c, w_u, w_v):
    N, D = x.shape
    hv = x @ w_v
    g = x[dst] @ w_a + x[src] @ w_b + e_attr @ w_c
    eta = _sigmoid(g)
    denom = _segment_sum(eta, dst, N) + 1e-6
    eta_n = eta / denom[dst]
    agg = _segment_sum(eta_n * hv[src], dst, N)
    z = x @ w_u + agg
    relu_z = torch.where(z > 0, z, 0 * z)
    return x + relu_z
```

```asm
; @launch kernel=gcn_prep_kernel grid=(256,1,1) block=(512,1,1) lds=114688
; @launch kernel=gcn_edge_kernel grid=(256,1,1) block=(512,1,1) lds=162048
.amdgcn_target "amdgcn-amd-amdhsa--gfx950"
.text
.globl gcn_prep_kernel
.p2align 8
.type gcn_prep_kernel,@function
gcn_prep_kernel:
    s_cmp_ge_u32 s2, 256
    s_cbranch_scc1 L_k1_exit
    s_load_dwordx16 s[16:31], s[0:1], 0
    s_load_dwordx8 s[32:39], s[0:1], 64
    v_and_b32 v1, 63, v0
    v_lshrrev_b32 v2, 6, v0
    s_nop 0
    v_readfirstlane_b32 s3, v2
    s_waitcnt lgkmcnt(0)
    s_cmp_lt_u32 s2, 2
    s_cbranch_scc1 L_k1_frag
    s_cmp_ge_u32 s2, 128
    s_cbranch_scc1 L_k1_t1
    s_cmp_eq_u32 s2, 127
    s_cbranch_scc1 L_k1_pad
    s_sub_u32 s15, s2, 2
    s_mov_b32 s40, s22
    s_mov_b32 s41, s23
    s_mov_b32 s42, 640000
    s_mov_b32 s43, 0x20000
    s_mul_i32 s4, s15, 1280
    v_add_u32 v3, s4, v0
    v_lshlrev_b32 v2, 2, v3
    s_movk_i32 s5, 4096
    buffer_load_dword v4, v2, s[40:43], 0 offen offset:0
    buffer_load_dword v5, v2, s[40:43], 0 offen offset:2048
    buffer_load_dword v6, v2, s[40:43], s5 offen
    s_mov_b32 s44, s20
    s_mov_b32 s45, s21
    s_mov_b32 s46, 640000
    s_mov_b32 s47, 0x20000
    buffer_load_dword v7, v2, s[44:47], 0 offen offset:0
    buffer_load_dword v8, v2, s[44:47], 0 offen offset:2048
    buffer_load_dword v9, v2, s[44:47], s5 offen
    v_lshlrev_b32 v45, 2, v0
    v_mov_b32 v46, 0
    ds_write_b32 v45, v46 offset:0
    ds_write_b32 v46, v46 offset:4096
    v_mov_b32 v60, -1
    v_mov_b32 v61, -1
    v_mov_b32 v62, -1
    v_mov_b32 v63, -1
    v_lshlrev_b32 v47, 4, v0
    ds_write_b128 v47, v[60:63] offset:12032
    ds_write_b128 v47, v[60:63] offset:20224
    v_mov_b32 v50, 1
    s_mov_b32 s48, s18
    s_mov_b32 s49, s19
    s_mov_b32 s50, 5120000
    s_mov_b32 s51, 0x20000
    s_mov_b32 s52, s38
    s_mov_b32 s53, s39
    s_mov_b32 s54, 13314048
    s_mov_b32 s55, 0x20000
    s_movk_i32 s8, 256
    v_cmp_gt_u32 s[64:65], s8, v0
    s_mov_b32 s9, 219902326
    s_movk_i32 s10, 625
    s_movk_i32 s6, 16384
    s_mov_b32 s7, 32768
    s_waitcnt lgkmcnt(0)
    s_barrier
    s_waitcnt vmcnt(5)
    v_mul_hi_u32 v42, v4, s9
    v_lshlrev_b32 v36, 2, v42
    ds_add_rtn_u32 v39, v36, v50 offset:0
    s_waitcnt vmcnt(4)
    v_mul_hi_u32 v43, v5, s9
    v_lshlrev_b32 v37, 2, v43
    ds_add_rtn_u32 v40, v37, v50 offset:0
    s_waitcnt vmcnt(3)
    v_mul_hi_u32 v44, v6, s9
    v_lshlrev_b32 v38, 2, v44
    s_mov_b64 exec, s[64:65]
    ds_add_rtn_u32 v41, v38, v50 offset:0
    s_mov_b64 exec, -1
    v_mad_u32_u24 v46, v42, s10, 31
    v_lshrrev_b32 v46, 5, v46
    v_sub_u32 v46, v4, v46
    v_and_b32 v47, 0x13, v46
    v_lshlrev_b32 v47, 1, v47
    v_and_b32 v48, 4, v46
    v_lshl_or_b32 v47, v48, 2, v47
    v_and_or_b32 v47, v46, 8, v47
    v_and_b32 v42, 3, v42
    v_lshlrev_b32 v42, 22, v42
    v_lshl_or_b32 v42, v47, 16, v42
    v_mad_u32_u24 v46, v43, s10, 31
    v_lshrrev_b32 v46, 5, v46
    v_sub_u32 v46, v5, v46
    v_and_b32 v47, 0x13, v46
    v_lshlrev_b32 v47, 1, v47
    v_and_b32 v48, 4, v46
    v_lshl_or_b32 v47, v48, 2, v47
    v_and_or_b32 v47, v46, 8, v47
    v_and_b32 v43, 3, v43
    v_lshlrev_b32 v43, 22, v43
    v_lshl_or_b32 v43, v47, 16, v43
    v_mad_u32_u24 v46, v44, s10, 31
    v_lshrrev_b32 v46, 5, v46
    v_sub_u32 v46, v6, v46
    v_and_b32 v47, 0x13, v46
    v_lshlrev_b32 v47, 1, v47
    v_and_b32 v48, 4, v46
    v_lshl_or_b32 v47, v48, 2, v47
    v_and_or_b32 v47, v46, 8, v47
    v_and_b32 v44, 3, v44
    v_lshlrev_b32 v44, 22, v44
    v_lshl_or_b32 v44, v47, 16, v44
    s_waitcnt vmcnt(2)
    v_or_b32 v42, v42, v7
    s_waitcnt vmcnt(1)
    v_or_b32 v43, v43, v8
    s_waitcnt vmcnt(0)
    v_or_b32 v44, v44, v9
    s_waitcnt lgkmcnt(0)
    s_barrier
    s_mul_i32 s11, s15, 40960
    s_lshl_b32 s12, s3, 10
    s_add_u32 s11, s11, s12
    s_add_u32 s12, s12, 28416
    v_lshlrev_b32 v3, 4, v1
    s_add_u32 m0, s12, 0
    s_add_u32 s13, s11, 0
    buffer_load_dwordx4 v3, s[48:51], s13 offen lds
    s_add_u32 m0, s12, 8192
    s_add_u32 s13, s11, 8192
    buffer_load_dwordx4 v3, s[48:51], s13 offen lds
    v_lshlrev_b32 v45, 5, v1
    ds_read_b128 v[60:63], v45 offset:0
    ds_read_b128 v[64:67], v45 offset:16
    s_waitcnt lgkmcnt(0)
    v_add3_u32 v46, v60, v61, v62
    v_add3_u32 v47, v63, v64, v65
    v_add3_u32 v46, v46, v66, v67
    v_add_u32 v46, v46, v47
    v_mov_b32 v47, v46
    s_nop 1
    v_add_u32_dpp v47, v47, v47 row_shr:1 row_mask:0xf bank_mask:0xf
    s_nop 1
    v_add_u32_dpp v47, v47, v47 row_shr:2 row_mask:0xf bank_mask:0xf
    s_nop 1
    v_add_u32_dpp v47, v47, v47 row_shr:4 row_mask:0xf bank_mask:0xf
    s_nop 1
    v_add_u32_dpp v47, v47, v47 row_shr:8 row_mask:0xf bank_mask:0xf
    s_nop 1
    v_add_u32_dpp v47, v47, v47 row_bcast:15 row_mask:0xa bank_mask:0xf
    s_nop 1
    v_add_u32_dpp v47, v47, v47 row_bcast:31 row_mask:0xc bank_mask:0xf
    v_sub_u32 v68, v47, v46
    v_add_u32 v69, v68, v60
    v_add_u32 v70, v69, v61
    v_add_u32 v71, v70, v62
    v_add_u32 v72, v71, v63
    v_add_u32 v73, v72, v64
    v_add_u32 v74, v73, v65
    v_add_u32 v75, v74, v66
    ds_write_b128 v45, v[68:71] offset:2048
    ds_write_b128 v45, v[72:75] offset:2064
    ds_read_b32 v54, v36 offset:2048
    v_and_b32 v36, -16, v36
    ds_read_b32 v57, v36 offset:2048
    ds_read_b32 v55, v37 offset:2048
    v_and_b32 v37, -16, v37
    ds_read_b32 v58, v37 offset:2048
    ds_read_b32 v56, v38 offset:2048
    v_and_b32 v38, -16, v38
    ds_read_b32 v59, v38 offset:2048
    s_movk_i32 s5, 0x78
    s_cmp_gt_u32 s3, 1
    s_cbranch_scc1 L_bin_nooff
    v_add_u32 v79, v75, v67
    s_cmp_eq_u32 s3, 0
    s_cselect_b64 vcc, -1, 0
    v_cndmask_b32 v80, v72, v68, vcc
    v_cndmask_b32 v81, v73, v69, vcc
    v_cndmask_b32 v82, v74, v70, vcc
    v_cndmask_b32 v83, v75, v71, vcc
    v_cndmask_b32 v78, v79, v72, vcc
    v_lshl_or_b32 v76, v81, 16, v80
    v_lshl_or_b32 v77, v83, 16, v82
    v_lshlrev_b32 v84, 12, v1
    v_mov_b32 v79, 0
    s_and_b32 s11, s15, 7
    s_lshl_b32 s11, s11, 4
    s_lshr_b32 s12, s15, 3
    s_add_u32 s11, s11, s12
    s_lshl_b32 s11, s11, 4
    s_lshl_b32 s12, s3, 11
    s_add_u32 s11, s11, s12
    s_add_u32 s11, s11, 12977152
    buffer_store_dwordx4 v[76:79], v84, s[52:55], s11 offen
    s_sub_u32 s12, s15, 117
    s_cmp_ge_u32 s12, 3
    s_cbranch_scc1 L_bin_nooff
    v_mov_b32 v80, 0
    v_mov_b32 v81, 0
    v_mov_b32 v82, 0
    v_mov_b32 v83, 0
    buffer_store_dwordx4 v[80:83], v84, s[52:55], s11 offen offset:16
L_bin_nooff:
    s_waitcnt lgkmcnt(0)
    s_movk_i32 s13, 32
    v_add_u32 v54, v54, v39
    v_sub_u32 v57, v54, v57
    v_lshlrev_b32 v46, 2, v54
    v_lshlrev_b32 v47, 1, v54
    v_add_u32 v49, 0, v0
    v_lshrrev_b32 v48, 2, v57
    v_and_b32 v48, 4, v48
    v_lshlrev_b32 v78, 3, v57
    v_and_or_b32 v48, v78, s5, v48
    v_lshl_add_u32 v48, v36, 3, v48
    v_cmp_gt_u32 vcc, s13, v57
    ds_write_b32 v46, v42 offset:6912
    ds_write_b16 v47, v49 offset:4352
    s_and_b64 exec, exec, vcc
    ds_write_b32 v48, v42 offset:12032
    s_andn2_b64 exec, -1, vcc
    s_cbranch_execz L_bin_noovf0
    v_mov_b32 v47, 0
    ds_write_b32 v47, v50 offset:4096
L_bin_noovf0:
    s_mov_b64 exec, -1
    v_add_u32 v55, v55, v40
    v_sub_u32 v58, v55, v58
    v_lshlrev_b32 v46, 2, v55
    v_lshlrev_b32 v47, 1, v55
    v_add_u32 v49, 512, v0
    v_lshrrev_b32 v48, 2, v58
    v_and_b32 v48, 4, v48
    v_lshlrev_b32 v78, 3, v58
    v_and_or_b32 v48, v78, s5, v48
    v_lshl_add_u32 v48, v37, 3, v48
    v_cmp_gt_u32 vcc, s13, v58
    ds_write_b32 v46, v43 offset:6912
    ds_write_b16 v47, v49 offset:4352
    s_and_b64 exec, exec, vcc
    ds_write_b32 v48, v43 offset:12032
    s_andn2_b64 exec, -1, vcc
    s_cbranch_execz L_bin_noovf1
    v_mov_b32 v47, 0
    ds_write_b32 v47, v50 offset:4096
L_bin_noovf1:
    s_mov_b64 exec, -1
    v_add_u32 v56, v56, v41
    v_sub_u32 v59, v56, v59
    v_lshlrev_b32 v46, 2, v56
    v_lshlrev_b32 v47, 1, v56
    v_add_u32 v49, 1024, v0
    v_lshrrev_b32 v48, 2, v59
    v_and_b32 v48, 4, v48
    v_lshlrev_b32 v78, 3, v59
    v_and_or_b32 v48, v78, s5, v48
    v_lshl_add_u32 v48, v38, 3, v48
    v_cmp_gt_u32 vcc, s13, v59
    s_mov_b64 exec, s[64:65]
    ds_write_b32 v46, v44 offset:6912
    ds_write_b16 v47, v49 offset:4352
    s_and_b64 exec, exec, vcc
    ds_write_b32 v48, v44 offset:12032
    s_andn2_b64 exec, s[64:65], vcc
    s_cbranch_execz L_bin_noovf2
    v_mov_b32 v47, 0
    ds_write_b32 v47, v50 offset:4096
L_bin_noovf2:
    s_mov_b64 exec, -1
    s_mul_i32 s11, s15, 40960
    s_lshl_b32 s12, s3, 10
    s_add_u32 s11, s11, s12
    s_add_u32 s12, s12, 28416
    v_lshlrev_b32 v3, 4, v1
    s_add_u32 m0, s12, 16384
    s_add_u32 s13, s11, 16384
    buffer_load_dwordx4 v3, s[48:51], s13 offen lds
    s_add_u32 m0, s12, 24576
    s_add_u32 s13, s11, 24576
    buffer_load_dwordx4 v3, s[48:51], s13 offen lds
    s_add_u32 m0, s12, 32768
    s_add_u32 s13, s11, 32768
    buffer_load_dwordx4 v3, s[48:51], s13 offen lds
    s_waitcnt vmcnt(0) lgkmcnt(0)
    s_barrier
    v_lshlrev_b32 v45, 2, v0
    v_lshlrev_b32 v46, 4, v0
    v_and_b32 v47, -2, v0
    ds_read_u16 v40, v47 offset:4352
    ds_read_u16 v41, v47 offset:4864
    ds_read_u16 v42, v47 offset:5376
    ds_read_u16 v43, v47 offset:5888
    ds_read_u16 v44, v47 offset:6400
    v_and_b32 v48, 1, v0
    v_lshlrev_b32 v48, 4, v48
    s_waitcnt lgkmcnt(4)
    v_lshl_add_u32 v40, v40, 5, v48
    ds_read_b128 v[12:15], v40 offset:28416
    s_waitcnt lgkmcnt(4)
    v_lshl_add_u32 v41, v41, 5, v48
    ds_read_b128 v[16:19], v41 offset:28416
    s_waitcnt lgkmcnt(4)
    v_lshl_add_u32 v42, v42, 5, v48
    ds_read_b128 v[20:23], v42 offset:28416
    s_waitcnt lgkmcnt(4)
    v_lshl_add_u32 v43, v43, 5, v48
    ds_read_b128 v[24:27], v43 offset:28416
    s_waitcnt lgkmcnt(4)
    v_lshl_add_u32 v44, v44, 5, v48
    ds_read_b128 v[28:31], v44 offset:28416
    ds_read_b128 v[32:35], v46 offset:12032
    ds_read_b128 v[36:39], v46 offset:20224
    ds_read_b32 v4, v45 offset:6912
    ds_read_b32 v5, v45 offset:8960
    ds_read_b32 v6, v45 offset:11008
    v_mov_b32 v49, 0
    ds_read_b32 v49, v49 offset:4096
    s_mul_i32 s14, s15, 40960
    s_add_u32 s14, s14, 5120000
    v_add_u32 v47, s14, v46
    s_movk_i32 s4, 8192
    s_movk_i32 s14, 24576
    s_waitcnt lgkmcnt(10)
    buffer_store_dwordx4 v[12:15], v47, s[52:55], 0 offen sc0 sc1
    s_waitcnt lgkmcnt(9)
    buffer_store_dwordx4 v[16:19], v47, s[52:55], s4 offen sc0 sc1
    s_waitcnt lgkmcnt(8)
    buffer_store_dwordx4 v[20:23], v47, s[52:55], s6 offen sc0 sc1
    s_waitcnt lgkmcnt(7)
    buffer_store_dwordx4 v[24:27], v47, s[52:55], s14 offen sc0 sc1
    s_waitcnt lgkmcnt(6)
    buffer_store_dwordx4 v[28:31], v47, s[52:55], s7 offen sc0 sc1
    v_lshrrev_b32 v47, 3, v0
    v_lshlrev_b32 v47, 14, v47
    v_and_b32 v48, 7, v0
    v_lshl_add_u32 v47, v48, 4, v47
    s_lshl_b32 s11, s15, 7
    s_add_u32 s11, s11, 10880000
    s_add_u32 s12, s11, 1048576
    s_waitcnt lgkmcnt(0)
    buffer_store_dwordx4 v[32:35], v47, s[52:55], s11 offen sc0 sc1
    buffer_store_dwordx4 v[36:39], v47, s[52:55], s12 offen sc0 sc1
    s_waitcnt lgkmcnt(0)
    v_readfirstlane_b32 s13, v49
    s_nop 0
    s_cmp_eq_u32 s13, 0
    s_cbranch_scc1 L_bin_norec
    s_mul_i32 s11, s15, 5120
    s_add_u32 s11, s11, 10240000
    s_add_u32 s12, s11, 4096
    buffer_store_dword v4, v45, s[52:55], s11 offen offset:0 sc0 sc1
    buffer_store_dword v5, v45, s[52:55], s11 offen offset:2048 sc0 sc1
    s_mov_b64 exec, s[64:65]
    buffer_store_dword v6, v45, s[52:55], s12 offen sc0 sc1
L_bin_norec:
L_bin_done:
    s_endpgm
L_k1_pad:
    s_mov_b32 s40, s38
    s_mov_b32 s41, s39
    s_mov_b32 s42, 13314048
    s_mov_b32 s43, 0x20000
    v_mov_b32 v8, -1
    v_mov_b32 v9, -1
    v_mov_b32 v10, -1
    v_mov_b32 v11, -1
    s_mov_b32 s9, 178956971
    s_mov_b32 s10, 10896000
    v_add_u32 v3, 0, v0
    v_mul_hi_u32 v5, v3, s9
    v_mul_u32_u24 v6, 24, v5
    v_sub_u32 v6, v3, v6
    v_lshlrev_b32 v5, 14, v5
    v_lshl_add_u32 v5, v6, 4, v5
    buffer_store_dwordx4 v[8:11], v5, s[40:43], s10 offen
    v_add_u32 v3, 512, v0
    v_mul_hi_u32 v5, v3, s9
    v_mul_u32_u24 v6, 24, v5
    v_sub_u32 v6, v3, v6
    v_lshlrev_b32 v5, 14, v5
    v_lshl_add_u32 v5, v6, 4, v5
    buffer_store_dwordx4 v[8:11], v5, s[40:43], s10 offen
    v_add_u32 v3, 1024, v0
    v_mul_hi_u32 v5, v3, s9
    v_mul_u32_u24 v6, 24, v5
    v_sub_u32 v6, v3, v6
    v_lshlrev_b32 v5, 14, v5
    v_lshl_add_u32 v5, v6, 4, v5
    buffer_store_dwordx4 v[8:11], v5, s[40:43], s10 offen
    v_add_u32 v3, 1536, v0
    v_mul_hi_u32 v5, v3, s9
    v_mul_u32_u24 v6, 24, v5
    v_sub_u32 v6, v3, v6
    v_lshlrev_b32 v5, 14, v5
    v_lshl_add_u32 v5, v6, 4, v5
    buffer_store_dwordx4 v[8:11], v5, s[40:43], s10 offen
    v_add_u32 v3, 2048, v0
    v_mul_hi_u32 v5, v3, s9
    v_mul_u32_u24 v6, 24, v5
    v_sub_u32 v6, v3, v6
    v_lshlrev_b32 v5, 14, v5
    v_lshl_add_u32 v5, v6, 4, v5
    buffer_store_dwordx4 v[8:11], v5, s[40:43], s10 offen
    v_add_u32 v3, 2560, v0
    v_mul_hi_u32 v5, v3, s9
    v_mul_u32_u24 v6, 24, v5
    v_sub_u32 v6, v3, v6
    v_lshlrev_b32 v5, 14, v5
    v_lshl_add_u32 v5, v6, 4, v5
    buffer_store_dwordx4 v[8:11], v5, s[40:43], s10 offen
    s_endpgm
L_k1_t1:
    s_sub_u32 s8, s2, 128
    s_and_b32 s5, s8, 1
    s_bfe_u32 s4, s8, 0x20001
    s_lshl_b32 s4, s4, 4
    s_lshr_b32 s11, s8, 3
    s_add_u32 s4, s4, s11
    s_mov_b32 s40, s16
    s_mov_b32 s41, s17
    s_mov_b32 s42, 2560000
    s_mov_b32 s43, 0x20000
    s_mul_i32 s6, s4, 5000
    s_add_u32 s9, s6, 5031
    s_add_u32 s6, s6, 31
    s_lshr_b32 s6, s6, 5
    s_lshr_b32 s9, s9, 5
    s_sub_u32 s7, s9, s6
    v_lshrrev_b32 v96, 4, v1
    s_mul_i32 s12, s3, 20
    v_add_u32 v96, s12, v96
    v_and_b32 v98, 15, v1
    s_mul_i32 s13, s3, 5120
    s_add_u32 s13, s13, 32768
    s_lshl_b32 s14, s6, 8
    s_mov_b32 s44, s26
    s_mov_b32 s45, s27
    s_mov_b32 s46, 32768
    s_mov_b32 s47, 0x20000
    s_cmp_ge_u32 s3, 4
    s_cselect_b32 s44, s32, s26
    s_cselect_b32 s45, s33, s27
    s_sub_u32 s8, s2, 128
    s_bfe_u32 s8, s8, 0x40003
    s_lshl_b32 s8, s8, 3
    s_and_b32 s9, s3, 3
    s_lshl_b32 s9, s9, 1
    s_add_u32 s8, s8, s9
    s_lshl_b32 s8, s8, 8
    s_lshl_b32 s9, s5, 7
    s_add_u32 s8, s8, s9
    v_and_b32 v101, 1, v1
    v_lshlrev_b32 v101, 8, v101
    s_mov_b64 exec, 3
    buffer_load_dword v108, v101, s[44:47], s8 offen
    s_mov_b64 exec, -1
    v_add_u32 v99, 0, v96
    v_and_b32 v100, 15, v99
    v_xor_b32 v100, v100, v98
    v_lshlrev_b32 v99, 8, v99
    v_lshl_add_u32 v99, v100, 4, v99
    s_add_u32 m0, s13, 0
    s_nop 0
    buffer_load_dwordx4 v99, s[40:43], s14 offen lds
    v_add_u32 v99, 4, v96
    v_and_b32 v100, 15, v99
    v_xor_b32 v100, v100, v98
    v_lshlrev_b32 v99, 8, v99
    v_lshl_add_u32 v99, v100, 4, v99
    s_add_u32 m0, s13, 1024
    s_nop 0
    buffer_load_dwordx4 v99, s[40:43], s14 offen lds
    v_add_u32 v99, 8, v96
    v_and_b32 v100, 15, v99
    v_xor_b32 v100, v100, v98
    v_lshlrev_b32 v99, 8, v99
    v_lshl_add_u32 v99, v100, 4, v99
    s_add_u32 m0, s13, 2048
    s_nop 0
    buffer_load_dwordx4 v99, s[40:43], s14 offen lds
    v_add_u32 v99, 12, v96
    v_and_b32 v100, 15, v99
    v_xor_b32 v100, v100, v98
    v_lshlrev_b32 v99, 8, v99
    v_lshl_add_u32 v99, v100, 4, v99
    s_add_u32 m0, s13, 3072
    s_nop 0
    buffer_load_dwordx4 v99, s[40:43], s14 offen lds
    v_add_u32 v99, 16, v96
    v_and_b32 v100, 15, v99
    v_xor_b32 v100, v100, v98
    v_lshlrev_b32 v99, 8, v99
    v_lshl_add_u32 v99, v100, 4, v99
    s_add_u32 m0, s13, 4096
    s_nop 0
    buffer_load_dwordx4 v99, s[40:43], s14 offen lds
    s_barrier
    v_lshrrev_b32 v96, 3, v1
    v_and_b32 v97, 7, v1
    v_lshrrev_b32 v98, 2, v1
    v_and_b32 v98, 4, v98
    v_xor_b32 v97, v97, v98
    v_lshlrev_b32 v97, 4, v97
    v_lshl_add_u32 v97, v96, 8, v97
    s_and_b32 s8, s3, 3
    s_lshl_b32 s9, s8, 13
    s_lshl_b32 s10, s5, 7
    s_add_u32 s9, s9, s10
    s_lshl_b32 s11, s3, 12
    s_add_u32 m0, s11, 0
    s_add_u32 s12, s9, 0
    buffer_load_dwordx4 v97, s[44:47], s12 offen lds
    s_add_u32 m0, s11, 1024
    s_add_u32 s12, s9, 2048
    buffer_load_dwordx4 v97, s[44:47], s12 offen lds
    s_add_u32 m0, s11, 2048
    s_add_u32 s12, s9, 4096
    buffer_load_dwordx4 v97, s[44:47], s12 offen lds
    s_add_u32 m0, s11, 3072
    s_add_u32 s12, s9, 6144
    buffer_load_dwordx4 v97, s[44:47], s12 offen lds
    s_mov_b32 s52, s38
    s_mov_b32 s53, s39
    s_mov_b32 s54, 5120000
    s_mov_b32 s55, 0x20000
    v_bfrev_b32 v107, 1
    v_and_b32 v105, 31, v1
    v_lshrrev_b32 v106, 5, v1
    s_and_b32 s8, s3, 1
    s_bfe_u32 s9, s3, 0x10001
    v_bfe_u32 v96, v1, 2, 2
    v_lshl_add_u32 v97, v106, 3, v96
    v_lshlrev_b32 v97, 7, v97
    v_bfe_u32 v98, v1, 4, 1
    v_lshlrev_b32 v98, 1, v98
    v_bfe_u32 v99, v1, 1, 1
    v_or_b32 v98, v98, v99
    s_lshl_b32 s10, s9, 2
    v_or_b32 v98, s10, v98
    v_lshrrev_b32 v99, 1, v96
    v_lshlrev_b32 v99, 2, v99
    v_xor_b32 v98, v98, v99
    v_lshl_add_u32 v97, v98, 4, v97
    v_and_b32 v99, 1, v1
    v_lshl_add_u32 v97, v99, 3, v97
    s_lshl_b32 s10, s8, 14
    v_add_u32 v102, s10, v97
    v_and_b32 v96, 15, v105
    v_xor_b32 v96, v96, v106
    v_lshlrev_b32 v96, 4, v96
    v_lshl_add_u32 v96, v105, 8, v96
    s_lshr_b32 s10, s3, 2
    s_mul_i32 s14, s10, 96
    s_mul_i32 s10, s10, 24576
    s_add_u32 s10, s10, 32768
    v_add_u32 v103, s10, v96
    s_lshl_b32 s10, s5, 1
    s_add_u32 s10, s10, s9
    s_mul_i32 s10, s10, 1280000
    s_lshl_b32 s11, s8, 6
    s_add_u32 s10, s10, s11
    s_add_u32 s11, s6, s14
    s_lshl_b32 s11, s11, 7
    s_add_u32 s10, s10, s11
    v_lshlrev_b32 v104, 7, v105
    v_lshl_add_u32 v104, v106, 4, v104
    v_add_u32 v104, s10, v104
    s_lshl_b32 s10, s8, 2
    v_or_b32 v96, s10, v106
    v_and_b32 v97, 7, v105
    v_xor_b32 v96, v96, v97
    v_lshlrev_b32 v96, 4, v96
    v_lshl_add_u32 v96, v105, 7, v96
    s_mul_i32 s10, s9, 20480
    s_lshl_b32 s11, s14, 7
    s_add_u32 s10, s10, s11
    s_add_u32 s10, s10, 73728
    v_add_u32 v109, s10, v96
    s_cmp_eq_u32 s8, 0
    s_cselect_b32 s15, 0xbfb8aa3b, 1.0
    s_waitcnt vmcnt(0)
    s_barrier
    ds_read_b64_tr_b16 v[8:9], v102 offset:0
    ds_read_b64_tr_b16 v[10:11], v102 offset:512
    v_xor_b32 v96, 0, v103
    ds_read_b128 v[40:43], v96 offset:0
    ds_read_b64_tr_b16 v[12:13], v102 offset:2048
    ds_read_b64_tr_b16 v[14:15], v102 offset:2560
    v_xor_b32 v96, 32, v103
    ds_read_b128 v[44:47], v96 offset:0
    ds_read_b64_tr_b16 v[16:17], v102 offset:4096
    ds_read_b64_tr_b16 v[18:19], v102 offset:4608
    v_xor_b32 v96, 64, v103
    ds_read_b128 v[48:51], v96 offset:0
    ds_read_b64_tr_b16 v[20:21], v102 offset:6144
    ds_read_b64_tr_b16 v[22:23], v102 offset:6656
    v_xor_b32 v96, 96, v103
    ds_read_b128 v[52:55], v96 offset:0
    s_waitcnt lgkmcnt(9)
    v_mfma_f32_32x32x16_bf16 v[72:87], v[8:11], v[40:43], 0
    ds_read_b64_tr_b16 v[24:25], v102 offset:8192
    ds_read_b64_tr_b16 v[26:27], v102 offset:8704
    v_xor_b32 v96, 128, v103
    ds_read_b128 v[56:59], v96 offset:0
    s_waitcnt lgkmcnt(9)
    v_mfma_f32_32x32x16_bf16 v[72:87], v[12:15], v[44:47], v[72:87]
    ds_read_b64_tr_b16 v[28:29], v102 offset:10240
    ds_read_b64_tr_b16 v[30:31], v102 offset:10752
    v_xor_b32 v96, 160, v103
    ds_read_b128 v[60:63], v96 offset:0
    s_waitcnt lgkmcnt(9)
    v_mfma_f32_32x32x16_bf16 v[72:87], v[16:19], v[48:51], v[72:87]
    ds_read_b64_tr_b16 v[32:33], v102 offset:12288
    ds_read_b64_tr_b16 v[34:35], v102 offset:12800
    v_xor_b32 v96, 192, v103
    ds_read_b128 v[64:67], v96 offset:0
    s_waitcnt lgkmcnt(9)
    v_mfma_f32_32x32x16_bf16 v[72:87], v[20:23], v[52:55], v[72:87]
    ds_read_b64_tr_b16 v[36:37], v102 offset:14336
    ds_read_b64_tr_b16 v[38:39], v102 offset:14848
    v_xor_b32 v96, 224, v103
    ds_read_b128 v[68:71], v96 offset:0
    s_waitcnt lgkmcnt(9)
    v_mfma_f32_32x32x16_bf16 v[72:87], v[24:27], v[56:59], v[72:87]
    s_waitcnt lgkmcnt(6)
    v_mfma_f32_32x32x16_bf16 v[72:87], v[28:31], v[60:63], v[72:87]
    s_waitcnt lgkmcnt(3)
    v_mfma_f32_32x32x16_bf16 v[72:87], v[32:35], v[64:67], v[72:87]
    s_waitcnt lgkmcnt(0)
    v_mfma_f32_32x32x16_bf16 v[72:87], v[36:39], v[68:71], v[72:87]
    v_add_u32 v97, s14, v105
    v_cmp_gt_u32 vcc, s7, v97
    v_add_u32 v98, 0, v104
    s_nop 0
    v_cndmask_b32 v98, v107, v98, vcc
    s_nop 6
    v_mul_f32 v72, s15, v72
    v_mul_f32 v73, s15, v73
    v_mul_f32 v74, s15, v74
    v_mul_f32 v75, s15, v75
    v_mul_f32 v76, s15, v76
    v_mul_f32 v77, s15, v77
    v_mul_f32 v78, s15, v78
    v_mul_f32 v79, s15, v79
    v_mul_f32 v80, s15, v80
    v_mul_f32 v81, s15, v81
    v_mul_f32 v82, s15, v82
    v_mul_f32 v83, s15, v83
    v_mul_f32 v84, s15, v84
    v_mul_f32 v85, s15, v85
    v_mul_f32 v86, s15, v86
    v_mul_f32 v87, s15, v87
    v_cvt_pk_bf16_f32 v88, v72, v73
    v_cvt_pk_bf16_f32 v89, v74, v75
    v_cvt_pk_bf16_f32 v90, v76, v77
    v_cvt_pk_bf16_f32 v91, v78, v79
    v_cvt_pk_bf16_f32 v92, v80, v81
    v_cvt_pk_bf16_f32 v93, v82, v83
    v_cvt_pk_bf16_f32 v94, v84, v85
    v_cvt_pk_bf16_f32 v95, v86, v87
    v_permlane32_swap_b32 v88, v90
    v_permlane32_swap_b32 v89, v91
    v_permlane32_swap_b32 v92, v94
    v_permlane32_swap_b32 v93, v95
    v_xor_b32 v99, 0, v109
    ds_write_b128 v99, v[88:91] offset:0
    v_xor_b32 v99, 32, v109
    ds_write_b128 v99, v[92:95] offset:0
    v_xor_b32 v96, 0, v103
    ds_read_b128 v[40:43], v96 offset:8192
    v_xor_b32 v96, 32, v103
    ds_read_b128 v[44:47], v96 offset:8192
    v_xor_b32 v96, 64, v103
    ds_read_b128 v[48:51], v96 offset:8192
    v_xor_b32 v96, 96, v103
    ds_read_b128 v[52:55], v96 offset:8192
    s_waitcnt lgkmcnt(3)
    v_mfma_f32_32x32x16_bf16 v[72:87], v[8:11], v[40:43], 0
    v_xor_b32 v96, 128, v103
    ds_read_b128 v[56:59], v96 offset:8192
    s_waitcnt lgkmcnt(3)
    v_mfma_f32_32x32x16_bf16 v[72:87], v[12:15], v[44:47], v[72:87]
    v_xor_b32 v96, 160, v103
    ds_read_b128 v[60:63], v96 offset:8192
    s_waitcnt lgkmcnt(3)
    v_mfma_f32_32x32x16_bf16 v[72:87], v[16:19], v[48:51], v[72:87]
    v_xor_b32 v96, 192, v103
    ds_read_b128 v[64:67], v96 offset:8192
    s_waitcnt lgkmcnt(3)
    v_mfma_f32_32x32x16_bf16 v[72:87], v[20:23], v[52:55], v[72:87]
    v_xor_b32 v96, 224, v103
    ds_read_b128 v[68:71], v96 offset:8192
    s_waitcnt lgkmcnt(3)
    v_mfma_f32_32x32x16_bf16 v[72:87], v[24:27], v[56:59], v[72:87]
    s_waitcnt lgkmcnt(2)
    v_mfma_f32_32x32x16_bf16 v[72:87], v[28:31], v[60:63], v[72:87]
    s_waitcnt lgkmcnt(1)
    v_mfma_f32_32x32x16_bf16 v[72:87], v[32:35], v[64:67], v[72:87]
    s_waitcnt lgkmcnt(0)
    v_mfma_f32_32x32x16_bf16 v[72:87], v[36:39], v[68:71], v[72:87]
    v_add_u32 v97, s14, v105
    v_add_u32 v97, 32, v97
    v_cmp_gt_u32 vcc, s7, v97
    v_add_u32 v98, 4096, v104
    s_nop 0
    v_cndmask_b32 v98, v107, v98, vcc
    s_nop 5
    v_mul_f32 v72, s15, v72
    v_mul_f32 v73, s15, v73
    v_mul_f32 v74, s15, v74
    v_mul_f32 v75, s15, v75
    v_mul_f32 v76, s15, v76
    v_mul_f32 v77, s15, v77
    v_mul_f32 v78, s15, v78
    v_mul_f32 v79, s15, v79
    v_mul_f32 v80, s15, v80
    v_mul_f32 v81, s15, v81
    v_mul_f32 v82, s15, v82
    v_mul_f32 v83, s15, v83
    v_mul_f32 v84, s15, v84
    v_mul_f32 v85, s15, v85
    v_mul_f32 v86, s15, v86
    v_mul_f32 v87, s15, v87
    v_cvt_pk_bf16_f32 v88, v72, v73
    v_cvt_pk_bf16_f32 v89, v74, v75
    v_cvt_pk_bf16_f32 v90, v76, v77
    v_cvt_pk_bf16_f32 v91, v78, v79
    v_cvt_pk_bf16_f32 v92, v80, v81
    v_cvt_pk_bf16_f32 v93, v82, v83
    v_cvt_pk_bf16_f32 v94, v84, v85
    v_cvt_pk_bf16_f32 v95, v86, v87
    v_permlane32_swap_b32 v88, v90
    v_permlane32_swap_b32 v89, v91
    v_permlane32_swap_b32 v92, v94
    v_permlane32_swap_b32 v93, v95
    v_xor_b32 v99, 0, v109
    ds_write_b128 v99, v[88:91] offset:4096
    v_xor_b32 v99, 32, v109
    ds_write_b128 v99, v[92:95] offset:4096
    s_cmp_ge_u32 s3, 4
    s_cbranch_scc1 L_t1_done
    v_xor_b32 v96, 0, v103
    ds_read_b128 v[40:43], v96 offset:16384
    v_xor_b32 v96, 32, v103
    ds_read_b128 v[44:47], v96 offset:16384
    v_xor_b32 v96, 64, v103
    ds_read_b128 v[48:51], v96 offset:16384
    v_xor_b32 v96, 96, v103
    ds_read_b128 v[52:55], v96 offset:16384
    s_waitcnt lgkmcnt(3)
    v_mfma_f32_32x32x16_bf16 v[72:87], v[8:11], v[40:43], 0
    v_xor_b32 v96, 128, v103
    ds_read_b128 v[56:59], v96 offset:16384
    s_waitcnt lgkmcnt(3)
    v_mfma_f32_32x32x16_bf16 v[72:87], v[12:15], v[44:47], v[72:87]
    v_xor_b32 v96, 160, v103
    ds_read_b128 v[60:63], v96 offset:16384
    s_waitcnt lgkmcnt(3)
    v_mfma_f32_32x32x16_bf16 v[72:87], v[16:19], v[48:51], v[72:87]
    v_xor_b32 v96, 192, v103
    ds_read_b128 v[64:67], v96 offset:16384
    s_waitcnt lgkmcnt(3)
    v_mfma_f32_32x32x16_bf16 v[72:87], v[20:23], v[52:55], v[72:87]
    v_xor_b32 v96, 224, v103
    ds_read_b128 v[68:71], v96 offset:16384
    s_waitcnt lgkmcnt(3)
    v_mfma_f32_32x32x16_bf16 v[72:87], v[24:27], v[56:59], v[72:87]
    s_waitcnt lgkmcnt(2)
    v_mfma_f32_32x32x16_bf16 v[72:87], v[28:31], v[60:63], v[72:87]
    s_waitcnt lgkmcnt(1)
    v_mfma_f32_32x32x16_bf16 v[72:87], v[32:35], v[64:67], v[72:87]
    s_waitcnt lgkmcnt(0)
    v_mfma_f32_32x32x16_bf16 v[72:87], v[36:39], v[68:71], v[72:87]
    v_add_u32 v97, s14, v105
    v_add_u32 v97, 64, v97
    v_cmp_gt_u32 vcc, s7, v97
    v_add_u32 v98, 8192, v104
    s_nop 0
    v_cndmask_b32 v98, v107, v98, vcc
    s_nop 5
    v_mul_f32 v72, s15, v72
    v_mul_f32 v73, s15, v73
    v_mul_f32 v74, s15, v74
    v_mul_f32 v75, s15, v75
    v_mul_f32 v76, s15, v76
    v_mul_f32 v77, s15, v77
    v_mul_f32 v78, s15, v78
    v_mul_f32 v79, s15, v79
    v_mul_f32 v80, s15, v80
    v_mul_f32 v81, s15, v81
    v_mul_f32 v82, s15, v82
    v_mul_f32 v83, s15, v83
    v_mul_f32 v84, s15, v84
    v_mul_f32 v85, s15, v85
    v_mul_f32 v86, s15, v86
    v_mul_f32 v87, s15, v87
    v_cvt_pk_bf16_f32 v88, v72, v73
    v_cvt_pk_bf16_f32 v89, v74, v75
    v_cvt_pk_bf16_f32 v90, v76, v77
    v_cvt_pk_bf16_f32 v91, v78, v79
    v_cvt_pk_bf16_f32 v92, v80, v81
    v_cvt_pk_bf16_f32 v93, v82, v83
    v_cvt_pk_bf16_f32 v94, v84, v85
    v_cvt_pk_bf16_f32 v95, v86, v87
    v_permlane32_swap_b32 v88, v90
    v_permlane32_swap_b32 v89, v91
    v_permlane32_swap_b32 v92, v94
    v_permlane32_swap_b32 v93, v95
    v_xor_b32 v99, 0, v109
    ds_write_b128 v99, v[88:91] offset:8192
    v_xor_b32 v99, 32, v109
    ds_write_b128 v99, v[92:95] offset:8192
L_t1_done:
    s_waitcnt lgkmcnt(0)
    s_barrier
    v_lshlrev_b32 v96, 4, v1
    s_mul_i32 s10, s3, 5120
    s_add_u32 s10, s10, 73728
    v_add_u32 v96, s10, v96
    ds_read_b128 v[8:11], v96 offset:0
    ds_read_b128 v[12:15], v96 offset:1024
    ds_read_b128 v[16:19], v96 offset:2048
    ds_read_b128 v[20:23], v96 offset:3072
    ds_read_b128 v[24:27], v96 offset:4096
    v_lshrrev_b32 v97, 3, v1
    v_and_b32 v98, 7, v1
    v_xor_b32 v98, v98, v97
    v_lshlrev_b32 v98, 4, v98
    v_lshl_add_u32 v98, v97, 7, v98
    s_lshr_b32 s9, s3, 2
    s_and_b32 s10, s3, 3
    s_mul_i32 s10, s10, 40
    s_lshl_b32 s11, s5, 1
    s_add_u32 s11, s11, s9
    s_mul_i32 s11, s11, 1280000
    s_add_u32 s12, s6, s10
    s_lshl_b32 s12, s12, 7
    s_add_u32 s11, s11, s12
    v_add_u32 v99, s10, v97
    v_cmp_gt_u32 vcc, s7, v99
    s_nop 1
    v_cndmask_b32 v100, v107, v98, vcc
    s_waitcnt lgkmcnt(4)
    buffer_store_dwordx4 v[8:11], v100, s[52:55], s11 offen offset:0 sc0 sc1
    v_add_u32 v99, s10, v97
    v_add_u32 v99, 8, v99
    v_cmp_gt_u32 vcc, s7, v99
    s_nop 1
    v_cndmask_b32 v100, v107, v98, vcc
    s_waitcnt lgkmcnt(3)
    buffer_store_dwordx4 v[12:15], v100, s[52:55], s11 offen offset:1024 sc0 sc1
    v_add_u32 v99, s10, v97
    v_add_u32 v99, 16, v99
    v_cmp_gt_u32 vcc, s7, v99
    s_nop 1
    v_cndmask_b32 v100, v107, v98, vcc
    s_waitcnt lgkmcnt(2)
    buffer_store_dwordx4 v[16:19], v100, s[52:55], s11 offen offset:2048 sc0 sc1
    v_add_u32 v99, s10, v97
    v_add_u32 v99, 24, v99
    v_cmp_gt_u32 vcc, s7, v99
    s_nop 1
    v_cndmask_b32 v100, v107, v98, vcc
    s_waitcnt lgkmcnt(1)
    buffer_store_dwordx4 v[20:23], v100, s[52:55], s11 offen offset:3072 sc0 sc1
    v_add_u32 v99, s10, v97
    v_add_u32 v99, 32, v99
    v_cmp_gt_u32 vcc, s7, v99
    s_nop 1
    v_cndmask_b32 v100, v107, v98, vcc
    s_add_u32 s11, s11, 4096
    s_waitcnt lgkmcnt(0)
    buffer_store_dwordx4 v[24:27], v100, s[52:55], s11 offen offset:0 sc0 sc1
    s_endpgm
L_k1_frag:
    s_cmp_eq_u32 s2, 0
    s_cselect_b32 s40, s24, s30
    s_cselect_b32 s41, s25, s31
    s_mov_b32 s42, 32768
    s_mov_b32 s43, 0x20000
    s_mov_b32 s44, s28
    s_mov_b32 s45, s29
    s_mov_b32 s46, 4096
    s_mov_b32 s47, 0x20000
    s_add_u32 s48, s38, 13239296
    s_addc_u32 s49, s39, 0
    s_mov_b32 s50, 74752
    s_mov_b32 s51, 0x20000
    v_lshrrev_b32 v2, 4, v1
    v_and_b32 v3, 15, v1
    v_lshlrev_b32 v4, 2, v2
    v_xor_b32 v3, v3, v4
    v_lshlrev_b32 v3, 4, v3
    v_lshl_add_u32 v3, v2, 8, v3
    s_lshl_b32 s8, s3, 12
    s_add_u32 m0, s8, 0
    s_add_u32 s9, s8, 0
    buffer_load_dwordx4 v3, s[40:43], s9 offen lds
    s_add_u32 m0, s8, 1024
    s_add_u32 s9, s8, 1024
    buffer_load_dwordx4 v3, s[40:43], s9 offen lds
    s_add_u32 m0, s8, 2048
    s_add_u32 s9, s8, 2048
    buffer_load_dwordx4 v3, s[40:43], s9 offen lds
    s_add_u32 m0, s8, 3072
    s_add_u32 s9, s8, 3072
    buffer_load_dwordx4 v3, s[40:43], s9 offen lds
    s_and_b32 s10, s3, 3
    s_lshl_b32 s9, s10, 10
    s_add_u32 m0, s9, 32768
    s_nop 0
    buffer_load_dwordx4 v3, s[44:47], s9 offen lds
    v_lshrrev_b32 v2, 5, v1
    v_bfe_u32 v4, v1, 2, 2
    v_lshl_add_u32 v5, v2, 3, v4
    v_lshlrev_b32 v5, 8, v5
    v_bfe_u32 v6, v1, 4, 1
    v_lshlrev_b32 v6, 1, v6
    v_bfe_u32 v7, v1, 1, 1
    v_or_b32 v6, v6, v7
    s_lshl_b32 s11, s10, 2
    v_or_b32 v6, s11, v6
    v_lshlrev_b32 v4, 2, v4
    v_xor_b32 v6, v6, v4
    v_lshl_add_u32 v5, v6, 4, v5
    v_and_b32 v7, 1, v1
    v_lshl_add_u32 v5, v7, 3, v5
    s_lshr_b32 s11, s3, 2
    s_lshl_b32 s12, s11, 14
    v_add_u32 v30, s12, v5
    s_cmp_eq_u32 s2, 0
    s_cselect_b32 s12, 0, 8192
    s_mul_i32 s13, s10, 17408
    s_add_u32 s12, s12, s13
    s_lshl_b32 s14, s11, 12
    s_add_u32 s12, s12, s14
    v_lshlrev_b32 v2, 4, v1
    v_add_u32 v3, s12, v2
    s_waitcnt vmcnt(0)
    s_barrier
    ds_read_b64_tr_b16 v[8:9], v30 offset:0
    ds_read_b64_tr_b16 v[10:11], v30 offset:1024
    ds_read_b64_tr_b16 v[12:13], v30 offset:4096
    ds_read_b64_tr_b16 v[14:15], v30 offset:5120
    ds_read_b64_tr_b16 v[16:17], v30 offset:8192
    ds_read_b64_tr_b16 v[18:19], v30 offset:9216
    ds_read_b64_tr_b16 v[20:21], v30 offset:12288
    ds_read_b64_tr_b16 v[22:23], v30 offset:13312
    ds_read_b64_tr_b16 v[24:25], v5 offset:32768
    ds_read_b64_tr_b16 v[26:27], v5 offset:33792
    s_waitcnt lgkmcnt(0)
    s_cmp_eq_u32 s2, 0
    s_cbranch_scc0 L_fr_u
    s_mov_b32 s12, 0xbfb8aa3b
    v_lshlrev_b32 v32, 16, v8
    v_and_b32 v33, 0xffff0000, v8
    v_lshlrev_b32 v34, 16, v9
    v_and_b32 v35, 0xffff0000, v9
    v_lshlrev_b32 v36, 16, v10
    v_and_b32 v37, 0xffff0000, v10
    v_lshlrev_b32 v38, 16, v11
    v_and_b32 v39, 0xffff0000, v11
    v_mul_f32 v32, s12, v32
    v_mul_f32 v33, s12, v33
    v_mul_f32 v34, s12, v34
    v_mul_f32 v35, s12, v35
    v_mul_f32 v36, s12, v36
    v_mul_f32 v37, s12, v37
    v_mul_f32 v38, s12, v38
    v_mul_f32 v39, s12, v39
    v_cvt_pk_bf16_f32 v8, v32, v33
    v_cvt_pk_bf16_f32 v9, v34, v35
    v_cvt_pk_bf16_f32 v10, v36, v37
    v_cvt_pk_bf16_f32 v11, v38, v39
    buffer_store_dwordx4 v[8:11], v3, s[48:51], 0 offen offset:0
    v_lshlrev_b32 v32, 16, v12
    v_and_b32 v33, 0xffff0000, v12
    v_lshlrev_b32 v34, 16, v13
    v_and_b32 v35, 0xffff0000, v13
    v_lshlrev_b32 v36, 16, v14
    v_and_b32 v37, 0xffff0000, v14
    v_lshlrev_b32 v38, 16, v15
    v_and_b32 v39, 0xffff0000, v15
    v_mul_f32 v32, s12, v32
    v_mul_f32 v33, s12, v33
    v_mul_f32 v34, s12, v34
    v_mul_f32 v35, s12, v35
    v_mul_f32 v36, s12, v36
    v_mul_f32 v37, s12, v37
    v_mul_f32 v38, s12, v38
    v_mul_f32 v39, s12, v39
    v_cvt_pk_bf16_f32 v12, v32, v33
    v_cvt_pk_bf16_f32 v13, v34, v35
    v_cvt_pk_bf16_f32 v14, v36, v37
    v_cvt_pk_bf16_f32 v15, v38, v39
    buffer_store_dwordx4 v[12:15], v3, s[48:51], 0 offen offset:1024
    v_lshlrev_b32 v32, 16, v16
    v_and_b32 v33, 0xffff0000, v16
    v_lshlrev_b32 v34, 16, v17
    v_and_b32 v35, 0xffff0000, v17
    v_lshlrev_b32 v36, 16, v18
    v_and_b32 v37, 0xffff0000, v18
    v_lshlrev_b32 v38, 16, v19
    v_and_b32 v39, 0xffff0000, v19
    v_mul_f32 v32, s12, v32
    v_mul_f32 v33, s12, v33
    v_mul_f32 v34, s12, v34
    v_mul_f32 v35, s12, v35
    v_mul_f32 v36, s12, v36
    v_mul_f32 v37, s12, v37
    v_mul_f32 v38, s12, v38
    v_mul_f32 v39, s12, v39
    v_cvt_pk_bf16_f32 v16, v32, v33
    v_cvt_pk_bf16_f32 v17, v34, v35
    v_cvt_pk_bf16_f32 v18, v36, v37
    v_cvt_pk_bf16_f32 v19, v38, v39
    buffer_store_dwordx4 v[16:19], v3, s[48:51], 0 offen offset:2048
    v_lshlrev_b32 v32, 16, v20
    v_and_b32 v33, 0xffff0000, v20
    v_lshlrev_b32 v34, 16, v21
    v_and_b32 v35, 0xffff0000, v21
    v_lshlrev_b32 v36, 16, v22
    v_and_b32 v37, 0xffff0000, v22
    v_lshlrev_b32 v38, 16, v23
    v_and_b32 v39, 0xffff0000, v23
    v_mul_f32 v32, s12, v32
    v_mul_f32 v33, s12, v33
    v_mul_f32 v34, s12, v34
    v_mul_f32 v35, s12, v35
    v_mul_f32 v36, s12, v36
    v_mul_f32 v37, s12, v37
    v_mul_f32 v38, s12, v38
    v_mul_f32 v39, s12, v39
    v_cvt_pk_bf16_f32 v20, v32, v33
    v_cvt_pk_bf16_f32 v21, v34, v35
    v_cvt_pk_bf16_f32 v22, v36, v37
    v_cvt_pk_bf16_f32 v23, v38, v39
    buffer_store_dwordx4 v[20:23], v3, s[48:51], 0 offen offset:3072
    s_cmp_ge_u32 s3, 4
    s_cbranch_scc1 L_fr_done
    v_lshlrev_b32 v32, 16, v24
    v_and_b32 v33, 0xffff0000, v24
    v_lshlrev_b32 v34, 16, v25
    v_and_b32 v35, 0xffff0000, v25
    v_lshlrev_b32 v36, 16, v26
    v_and_b32 v37, 0xffff0000, v26
    v_lshlrev_b32 v38, 16, v27
    v_and_b32 v39, 0xffff0000, v27
    v_mul_f32 v32, s12, v32
    v_mul_f32 v33, s12, v33
    v_mul_f32 v34, s12, v34
    v_mul_f32 v35, s12, v35
    v_mul_f32 v36, s12, v36
    v_mul_f32 v37, s12, v37
    v_mul_f32 v38, s12, v38
    v_mul_f32 v39, s12, v39
    v_cvt_pk_bf16_f32 v24, v32, v33
    v_cvt_pk_bf16_f32 v25, v34, v35
    v_cvt_pk_bf16_f32 v26, v36, v37
    v_cvt_pk_bf16_f32 v27, v38, v39
    s_add_u32 s13, s13, 16384
    v_add_u32 v2, s13, v2
    buffer_store_dwordx4 v[24:27], v2, s[48:51], 0 offen
    s_branch L_fr_done
L_fr_u:
    buffer_store_dwordx4 v[8:11], v3, s[48:51], 0 offen offset:0
    buffer_store_dwordx4 v[12:15], v3, s[48:51], 0 offen offset:1024
    buffer_store_dwordx4 v[16:19], v3, s[48:51], 0 offen offset:2048
    buffer_store_dwordx4 v[20:23], v3, s[48:51], 0 offen offset:3072
    s_cmp_lg_u32 s3, 0
    s_cbranch_scc1 L_fr_done
    v_and_b32 v40, 31, v1
    v_lshrrev_b32 v41, 5, v1
    v_mov_b32 v43, 0
    v_mov_b32 v42, 0x3f80
    v_lshlrev_b32 v44, 2, v41
    v_sub_u32 v44, v40, v44
    v_and_b32 v45, 1, v44
    v_lshlrev_b32 v45, 4, v45
    v_lshlrev_b32 v45, v45, v42
    v_ashrrev_i32 v44, 1, v44
    v_cmp_eq_u32 vcc, 0, v44
    s_nop 1
    v_cndmask_b32 v48, v43, v45, vcc
    v_cmp_eq_u32 vcc, 1, v44
    s_nop 1
    v_cndmask_b32 v49, v43, v45, vcc
    v_cmp_eq_u32 vcc, 4, v44
    s_nop 1
    v_cndmask_b32 v50, v43, v45, vcc
    v_cmp_eq_u32 vcc, 5, v44
    s_nop 1
    v_cndmask_b32 v51, v43, v45, vcc
    v_cmp_eq_u32 vcc, 8, v44
    s_nop 1
    v_cndmask_b32 v52, v43, v45, vcc
    v_cmp_eq_u32 vcc, 9, v44
    s_nop 1
    v_cndmask_b32 v53, v43, v45, vcc
    v_cmp_eq_u32 vcc, 12, v44
    s_nop 1
    v_cndmask_b32 v54, v43, v45, vcc
    v_cmp_eq_u32 vcc, 13, v44
    s_nop 1
    v_cndmask_b32 v55, v43, v45, vcc
    v_and_b32 v44, 3, v40
    s_mov_b32 s15, 0x55555555
    v_mul_lo_u32 v60, v44, s15
    v_bfe_u32 v44, v40, 2, 1
    v_bfe_u32 v45, v40, 3, 1
    v_lshl_or_b32 v44, v44, 1, v45
    v_lshrrev_b32 v45, 4, v40
    v_cmp_eq_u32 vcc, v45, v41
    s_nop 1
    v_cndmask_b32 v44, -1, v44, vcc
    v_cmp_eq_u32 vcc, 0, v44
    s_nop 1
    v_cndmask_b32 v56, v43, v42, vcc
    v_cmp_eq_u32 vcc, 1, v44
    s_nop 1
    v_cndmask_b32 v57, v43, v42, vcc
    v_cmp_eq_u32 vcc, 2, v44
    s_nop 1
    v_cndmask_b32 v58, v43, v42, vcc
    v_cmp_eq_u32 vcc, 3, v44
    s_nop 1
    v_cndmask_b32 v59, v43, v42, vcc
    v_bfe_u32 v70, v1, 2, 2
    v_bfe_u32 v71, v1, 4, 1
    v_bfe_u32 v72, v1, 1, 1
    v_and_b32 v73, 1, v1
    v_lshl_add_u32 v74, v41, 2, v70
    v_lshl_or_b32 v75, v71, 1, v72
    v_lshrrev_b32 v44, 1, v70
    v_lshlrev_b32 v44, 2, v44
    v_xor_b32 v44, v44, v75
    v_lshlrev_b32 v44, 4, v44
    v_lshl_add_u32 v44, v74, 7, v44
    v_lshl_add_u32 v61, v73, 3, v44
    v_lshl_or_b32 v75, v71, 1, v73
    v_xor_b32 v44, v75, v41
    v_lshlrev_b32 v44, 4, v44
    v_lshl_add_u32 v44, v74, 6, v44
    v_lshl_add_u32 v62, v72, 3, v44
    v_bfe_u32 v44, v40, 2, 2
    v_lshlrev_b32 v64, 4, v44
    v_lshlrev_b32 v65, 6, v40
    v_xor_b32 v44, v44, v41
    v_lshl_add_u32 v63, v44, 4, v65
    v_lshlrev_b32 v44, 2, v71
    v_and_b32 v75, 7, v1
    v_xor_b32 v44, v44, v75
    v_lshlrev_b32 v66, 4, v44
    v_lshlrev_b32 v67, 4, v41
    v_lshlrev_b32 v44, 4, v1
    s_mov_b32 s15, 69632
    buffer_store_dwordx4 v[48:51], v44, s[48:51], s15 offen offset:0
    buffer_store_dwordx4 v[52:55], v44, s[48:51], s15 offen offset:1024
    buffer_store_dwordx4 v[56:59], v44, s[48:51], s15 offen offset:2048
    buffer_store_dwordx4 v[60:63], v44, s[48:51], s15 offen offset:3072
    s_add_u32 s15, s15, 4096
    buffer_store_dwordx4 v[64:67], v44, s[48:51], s15 offen
L_fr_done:
    s_endpgm
L_k1_exit:
    s_endpgm
.globl gcn_edge_kernel
.p2align 8
.type gcn_edge_kernel,@function
gcn_edge_kernel:
    s_cmp_ge_u32 s2, 256
    s_cbranch_scc1 L_k2_exit
    s_load_dwordx16 s[16:31], s[0:1], 0
    s_load_dwordx8 s[32:39], s[0:1], 64
    v_and_b32 v1, 63, v0
    v_lshrrev_b32 v17, 6, v0
    s_nop 0
    v_readfirstlane_b32 s3, v17
    v_and_b32 v2, 31, v1
    v_lshrrev_b32 v3, 5, v1
    v_mov_b32 v14, 0
    v_mov_b32 v13, 0x3f80
    s_and_b32 s5, s2, 1
    s_bfe_u32 s4, s2, 0x20001
    s_lshl_b32 s4, s4, 5
    s_lshr_b32 s11, s2, 3
    s_add_u32 s4, s4, s11
    s_lshr_b32 s11, s3, 2
    s_lshl_b32 s12, s11, 1
    s_add_u32 s12, s12, s3
    s_and_b32 s6, s12, 3
    s_lshl_b32 s7, s5, 1
    s_add_u32 s7, s7, s11
    s_lshl_b32 s8, s4, 2
    s_add_u32 s8, s8, s6
    v_and_b32 v192, 15, v1
    v_lshrrev_b32 v17, 4, v1
    s_lshl_b32 s11, s3, 4
    v_add_u32 v17, s11, v17
    v_mul_u32_u24 v238, 1280, v17
    v_lshlrev_b32 v239, 4, v17
    v_lshlrev_b32 v30, 7, v17
    v_lshl_add_u32 v30, v192, 3, v30
    v_lshlrev_b32 v31, 1, v17
    v_lshlrev_b32 v20, 2, v1
    v_lshlrev_b32 v17, 4, v0
    v_mov_b32 v164, -1
    v_mov_b32 v165, -1
    v_mov_b32 v166, -1
    v_mov_b32 v167, -1
    ds_write_b128 v17, v[164:167] offset:0
    v_lshlrev_b32 v18, 3, v0
    ds_write_b64 v18, v[164:165] offset:9216
    v_mov_b32 v168, 0x3e003e
    v_mov_b32 v169, 0x3e003e
    ds_write_b64 v18, v[168:169] offset:13824
    v_lshlrev_b32 v17, 4, v1
    ds_write_b128 v17, v[164:167] offset:8192
    v_lshlrev_b32 v18, 3, v1
    ds_write_b64 v18, v[164:165] offset:13312
    ds_write_b64 v18, v[168:169] offset:17920
    s_lshl_b32 s65, s3, 11
    s_add_u32 s65, s65, 20736
    v_lshlrev_b32 v17, 5, v1
    v_add_u32 v17, s65, v17
    v_mov_b32 v172, 0
    v_mov_b32 v173, 0
    v_mov_b32 v174, 0
    v_mov_b32 v175, 0
    ds_write_b128 v17, v[172:175]
    ds_write_b128 v17, v[172:175] offset:16
    s_lshl_b32 s12, s4, 11
    s_add_u32 s12, s12, 12977152
    v_lshlrev_b32 v21, 4, v1
    s_lshl_b32 s15, s4, 14
    s_add_u32 s15, s15, 10880000
    s_waitcnt lgkmcnt(0)
    s_mov_b32 s52, s38
    s_mov_b32 s53, s39
    s_mov_b32 s54, 13314048
    s_mov_b32 s55, 0x20000
    buffer_load_dwordx3 v[180:182], v21, s[52:55], s12 offen
    buffer_load_dwordx3 v[184:186], v21, s[52:55], s12 offen offset:1024
    buffer_load_dwordx2 v[64:65], v30, s[52:55], s15 offen offset:0
    buffer_load_dwordx2 v[66:67], v30, s[52:55], s15 offen offset:512
    buffer_load_dwordx2 v[68:69], v30, s[52:55], s15 offen offset:1024
    buffer_load_dwordx2 v[70:71], v30, s[52:55], s15 offen offset:1536
    s_lshl_b32 s64, s3, 12
    s_add_u32 s64, s64, 37120
    v_bfe_u32 v164, v1, 2, 2
    v_bfe_u32 v165, v1, 4, 1
    v_bfe_u32 v166, v1, 1, 1
    v_and_b32 v167, 1, v1
    v_lshl_add_u32 v168, v3, 2, v164
    v_lshl_or_b32 v169, v165, 1, v166
    v_lshrrev_b32 v170, 1, v164
    v_lshlrev_b32 v170, 2, v170
    v_xor_b32 v170, v170, v169
    v_lshlrev_b32 v170, 4, v170
    v_lshl_add_u32 v170, v168, 7, v170
    v_lshl_add_u32 v170, v167, 3, v170
    v_add_u32 v11, s64, v170
    v_xor_b32 v12, 64, v11
    v_add_u32 v248, 0x10000, v11
    v_add_u32 v249, 0x10000, v12
    v_lshl_or_b32 v169, v165, 1, v167
    v_xor_b32 v170, v169, v3
    v_lshlrev_b32 v170, 4, v170
    v_lshl_add_u32 v170, v168, 6, v170
    v_lshl_add_u32 v170, v166, 3, v170
    v_add_u32 v9, s65, v170
    v_xor_b32 v10, 32, v9
    v_bfe_u32 v170, v2, 2, 2
    v_lshlrev_b32 v240, 4, v170
    v_lshl_add_u32 v241, v2, 6, s65
    v_xor_b32 v170, v170, v3
    v_lshl_add_u32 v7, v170, 4, v241
    v_xor_b32 v8, 32, v7
    v_lshlrev_b32 v170, 2, v165
    v_and_b32 v169, 7, v1
    v_xor_b32 v170, v170, v169
    v_lshlrev_b32 v23, 4, v170
    v_mov_b32 v25, v23
    v_mov_b32 v27, v23
    v_mov_b32 v29, v23
    v_lshlrev_b32 v21, 4, v3
    v_lshlrev_b32 v17, 2, v3
    v_sub_u32 v17, v2, v17
    v_and_b32 v18, 1, v17
    v_lshlrev_b32 v18, 4, v18
    v_lshlrev_b32 v18, v18, v13
    v_ashrrev_i32 v17, 1, v17
    v_cmp_eq_u32 s[88:89], 0, v17
    v_cmp_eq_u32 s[90:91], 1, v17
    v_cmp_eq_u32 s[92:93], 4, v17
    v_cmp_eq_u32 s[94:95], 5, v17
    v_cndmask_b32 v156, v14, v18, s[88:89]
    v_cndmask_b32 v157, v14, v18, s[90:91]
    v_cndmask_b32 v158, v14, v18, s[92:93]
    v_cndmask_b32 v159, v14, v18, s[94:95]
    v_cmp_eq_u32 s[88:89], 8, v17
    v_cmp_eq_u32 s[90:91], 9, v17
    v_cmp_eq_u32 s[92:93], 12, v17
    v_cmp_eq_u32 s[94:95], 13, v17
    v_cndmask_b32 v160, v14, v18, s[88:89]
    v_cndmask_b32 v161, v14, v18, s[90:91]
    v_cndmask_b32 v162, v14, v18, s[92:93]
    v_cndmask_b32 v163, v14, v18, s[94:95]
    v_and_b32 v17, 3, v2
    s_mov_b32 s87, 0x55555555
    v_mul_lo_u32 v254, v17, s87
    v_bfe_u32 v17, v2, 2, 1
    v_bfe_u32 v18, v2, 3, 1
    v_lshl_or_b32 v17, v17, 1, v18
    v_lshrrev_b32 v18, 4, v2
    v_cmp_eq_u32 vcc, v18, v3
    s_nop 1
    v_cndmask_b32 v17, -1, v17, vcc
    v_cmp_eq_u32 s[88:89], 0, v17
    v_cmp_eq_u32 s[90:91], 1, v17
    v_cmp_eq_u32 s[92:93], 2, v17
    v_cmp_eq_u32 s[94:95], 3, v17
    v_cndmask_b32 v250, v14, v13, s[88:89]
    v_cndmask_b32 v251, v14, v13, s[90:91]
    v_cndmask_b32 v252, v14, v13, s[92:93]
    v_cndmask_b32 v253, v14, v13, s[94:95]
    s_mul_i32 s11, s7, 1280000
    s_add_u32 s44, s38, s11
    s_addc_u32 s45, s39, 0
    s_or_b32 s45, s45, 8388608
    s_mov_b32 s46, 10000
    s_mov_b32 s47, 0x20000
    s_add_u32 s48, s38, 5120000
    s_addc_u32 s49, s39, 0
    s_or_b32 s49, s49, 2097152
    s_mov_b32 s50, 160000
    s_mov_b32 s51, 0x20000
    s_mov_b32 s56, s34
    s_mov_b32 s57, s35
    s_mov_b32 s58, 2560000
    s_mov_b32 s59, 0x20000
    s_movk_i32 s68, -576
    s_movk_i32 s69, 416
    s_mov_b32 s62, 0
    s_lshr_b32 s11, s3, 2
    s_mul_i32 s71, s11, 17408
    s_add_u32 s71, s71, 102656
    s_mul_i32 s11, s6, 576
    v_lshrrev_b32 v17, 3, v1
    v_add_lshl_u32 v4, v17, s11, 1
    v_add_lshl_u32 v5, v2, s11, 2
    v_lshrrev_b32 v6, 1, v5
    s_cmp_ge_u32 s6, 2
    s_cselect_b64 s[88:89], -1, 0
    s_cmp_eq_u32 s6, 0
    s_cselect_b64 s[90:91], -1, 0
    s_cmp_eq_u32 s6, 3
    s_cselect_b64 s[92:93], -1, 0
    s_and_b32 s94, s6, 1
    s_lshl_b32 s94, s94, 4
    s_xor_b32 s95, s94, 16
    v_and_b32 v19, 48, v1
    s_lshl_b32 s11, s3, 1
    v_add_lshl_u32 v19, v19, s11, 2
    v_and_b32 v17, 15, v1
    v_lshlrev_b32 v17, 7, v17
    v_and_b32 v18, 48, v1
    s_lshl_b32 s11, s6, 2
    v_add3_u32 v17, v17, v18, s11
    v_mov_b32 v31, v17
    s_waitcnt vmcnt(4)
    ds_bpermute_b32 v228, v19, v180 offset:0
    ds_bpermute_b32 v229, v19, v184 offset:0
    ds_bpermute_b32 v230, v19, v180 offset:4
    ds_bpermute_b32 v231, v19, v184 offset:4
    v_and_b32 v168, 0xffff, v180
    v_and_b32 v169, 0xffff, v184
    v_sub_u32 v170, v182, v168
    v_sub_u32 v171, v186, v169
    v_max_u32 v170, v170, v171
    v_cmp_lt_u32 vcc, 32, v170
    v_cndmask_b32 v164, v180, v181, s[88:89]
    v_cndmask_b32 v166, v181, v180, s[90:91]
    v_cndmask_b32 v166, v166, v182, s[92:93]
    v_bfe_u32 v164, v164, s94, 16
    v_bfe_u32 v166, v166, s95, 16
    v_cndmask_b32 v165, v184, v185, s[88:89]
    v_cndmask_b32 v167, v185, v184, s[90:91]
    v_cndmask_b32 v167, v167, v186, s[92:93]
    v_bfe_u32 v165, v165, s94, 16
    v_bfe_u32 v167, v167, s95, 16
    s_cmp_lg_u64 vcc, 0
    s_cselect_b32 s72, 1, 0
    v_sub_u32 v166, v166, v164
    v_sub_u32 v167, v167, v165
    v_add_u32 v167, v166, v167
    v_mov_b32 v168, v167
    s_nop 1
    v_add_u32_dpp v168, v168, v168 row_shr:1 row_mask:0xf bank_mask:0xf
    s_nop 1
    v_add_u32_dpp v168, v168, v168 row_shr:2 row_mask:0xf bank_mask:0xf
    s_nop 1
    v_add_u32_dpp v168, v168, v168 row_shr:4 row_mask:0xf bank_mask:0xf
    s_nop 1
    v_add_u32_dpp v168, v168, v168 row_shr:8 row_mask:0xf bank_mask:0xf
    s_nop 1
    v_add_u32_dpp v168, v168, v168 row_bcast:15 row_mask:0xa bank_mask:0xf
    s_nop 1
    v_add_u32_dpp v168, v168, v168 row_bcast:31 row_mask:0xc bank_mask:0xf
    s_nop 0
    v_readlane_b32 s61, v168, 63
    v_sub_u32 v168, v168, v167
    s_mul_i32 s11, s6, 576
    v_add_u32 v168, s11, v168
    v_and_b32 v169, 0xffff, v180
    v_sub_u32 v169, v169, v164
    v_add_u32 v236, v168, v169
    v_and_b32 v169, 0xffff, v184
    v_sub_u32 v169, v169, v165
    v_add3_u32 v237, v168, v166, v169
    ds_write_b32 v31, v236 offset:18432
    ds_write_b32 v31, v237 offset:18496
    s_lshl_b32 s11, s6, 2
    v_mov_b32 v18, s61
    v_mov_b32 v19, s11
    ds_write_b32 v19, v18 offset:20480
    s_mov_b32 s40, s16
    s_mov_b32 s41, s17
    s_mov_b32 s42, 2560000
    s_mov_b32 s43, 0x20000
    s_mul_i32 s11, s4, 2500
    s_add_u32 s11, s11, 31
    s_lshr_b32 s74, s11, 5
    s_mov_b32 s73, s6
    s_lshl_b32 s8, s4, 2
    s_add_u32 s8, s8, s6
    s_mul_i32 s12, s8, 625
    s_add_u32 s13, s12, 656
    s_add_u32 s12, s12, 31
    s_lshr_b32 s9, s12, 5
    s_lshr_b32 s13, s13, 5
    s_sub_u32 s10, s13, s9
    s_sub_u32 s70, s9, s74
    s_lshl_b32 s11, s74, 8
    v_lshrrev_b32 v18, 4, v1
    s_lshl_b32 s12, s3, 2
    v_add_u32 v18, s12, v18
    s_lshl_b32 s13, s3, 10
    s_add_u32 s13, s13, 137472
    v_add_u32 v164, 0, v18
    v_and_b32 v165, 15, v164
    v_xor_b32 v165, v165, v192
    v_lshlrev_b32 v164, 8, v164
    v_lshl_add_u32 v164, v165, 4, v164
    s_add_u32 m0, s13, 0
    s_nop 0
    buffer_load_dwordx4 v164, s[40:43], s11 offen lds
    v_add_u32 v164, 32, v18
    v_and_b32 v165, 15, v164
    v_xor_b32 v165, v165, v192
    v_lshlrev_b32 v164, 8, v164
    v_lshl_add_u32 v164, v165, 4, v164
    s_add_u32 m0, s13, 8192
    s_nop 0
    buffer_load_dwordx4 v164, s[40:43], s11 offen lds
    v_add_u32 v164, 64, v18
    v_and_b32 v165, 15, v164
    v_xor_b32 v165, v165, v192
    v_lshlrev_b32 v164, 8, v164
    v_lshl_add_u32 v164, v165, 4, v164
    s_add_u32 m0, s13, 16384
    s_nop 0
    buffer_load_dwordx4 v164, s[40:43], s11 offen lds
    v_lshlrev_b32 v17, 4, v1
    s_mul_i32 s11, s5, 34816
    s_add_u32 s11, s11, 13239296
    s_lshl_b32 s12, s3, 10
    s_add_u32 s11, s11, s12
    s_add_u32 s12, s12, 102656
    s_add_u32 m0, s12, 0
    s_nop 0
    buffer_load_dwordx4 v17, s[52:55], s11 offen lds
    s_add_u32 m0, s12, 8192
    s_add_u32 s11, s11, 8192
    buffer_load_dwordx4 v17, s[52:55], s11 offen lds
    s_add_u32 m0, s12, 16384
    s_add_u32 s11, s11, 8192
    buffer_load_dwordx4 v17, s[52:55], s11 offen lds
    s_add_u32 m0, s12, 24576
    s_add_u32 s11, s11, 8192
    buffer_load_dwordx4 v17, s[52:55], s11 offen lds
    s_cmp_ge_u32 s3, 2
    s_cbranch_scc1 L_no5
    s_add_u32 m0, s12, 32768
    s_add_u32 s11, s11, 8192
    buffer_load_dwordx4 v17, s[52:55], s11 offen lds
L_no5:
    s_mul_i32 s11, s5, 2560000
    s_add_u32 s76, s38, s11
    s_addc_u32 s77, s39, 0
    s_mov_b32 s78, 2560000
    s_mov_b32 s79, 0x20000
    s_lshr_b32 s11, s2, 3
    s_lshl_b32 s11, s11, 3
    s_add_u32 s11, s11, s3
    s_lshl_b32 s11, s11, 7
    v_lshlrev_b32 v17, 15, v1
    s_mov_b32 s78, 786432
    buffer_load_dword v30, v17, s[76:79], s11 offen
    v_add_u32 v17, v238, v192
    s_waitcnt lgkmcnt(3)
    v_and_b32 v228, 0xffff, v228
    v_add_u32 v72, v228, v17
    v_add_u32 v76, 16, v72
    v_and_b32 v229, 0xffff, v229
    v_add_u32 v73, v229, v17
    v_add_u32 v73, 5120, v73
    v_add_u32 v77, 16, v73
    v_and_b32 v230, 0xffff, v230
    v_add_u32 v74, v230, v17
    v_add_u32 v74, 10240, v74
    v_add_u32 v78, 16, v74
    v_and_b32 v231, 0xffff, v231
    v_add_u32 v75, v231, v17
    v_add_u32 v75, 15360, v75
    v_add_u32 v79, 16, v75
    s_waitcnt lgkmcnt(0)
    s_barrier
    ds_read_b128 v[188:191], v14 offset:20480
    s_waitcnt vmcnt(8)
    s_waitcnt lgkmcnt(0)
    v_max_u32 v188, v188, v189
    v_max3_u32 v188, v188, v190, v191
    s_nop 0
    v_readfirstlane_b32 s11, v188
    s_nop 0
    s_cmp_gt_u32 s11, 416
    s_cselect_b32 s72, 1, s72
    s_add_u32 s11, s11, 415
    s_mov_b32 s12, 10324441
    s_mul_hi_u32 s63, s11, s12
    s_cmp_lg_u32 s72, 0
    s_cbranch_scc1 L_slow0
    v_bfe_u32 v172, v64, 22, 2
    v_lshl_add_u32 v17, v172, 2, v239
    ds_read_b32 v164, v17 offset:18432
    v_bfe_u32 v173, v66, 22, 2
    v_lshl_add_u32 v17, v173, 2, v239
    ds_read_b32 v165, v17 offset:18496
    v_bfe_u32 v174, v68, 22, 2
    v_lshl_add_u32 v17, v174, 2, v239
    ds_read_b32 v166, v17 offset:18560
    v_bfe_u32 v175, v70, 22, 2
    v_lshl_add_u32 v17, v175, 2, v239
    ds_read_b32 v167, v17 offset:18624
    v_bfe_u32 v176, v65, 22, 2
    v_lshl_add_u32 v17, v176, 2, v239
    ds_read_b32 v168, v17 offset:18432
    v_bfe_u32 v177, v67, 22, 2
    v_lshl_add_u32 v17, v177, 2, v239
    ds_read_b32 v169, v17 offset:18496
    v_bfe_u32 v178, v69, 22, 2
    v_lshl_add_u32 v17, v178, 2, v239
    ds_read_b32 v170, v17 offset:18560
    v_bfe_u32 v179, v71, 22, 2
    v_lshl_add_u32 v17, v179, 2, v239
    ds_read_b32 v171, v17 offset:18624
    s_waitcnt lgkmcnt(0)
    v_cmp_ne_u32 vcc, -1, v64
    v_add_u32 v164, v192, v164
    v_lshlrev_b32 v17, 2, v164
    v_lshlrev_b32 v18, 1, v164
    s_mov_b64 exec, vcc
    ds_write_b32 v17, v72 offset:0
    ds_write_b16 v18, v64 offset:9216
    ds_write_b16_d16_hi v18, v64 offset:13824
    s_mov_b64 exec, -1
    v_cmp_ne_u32 vcc, -1, v66
    v_add_u32 v165, v192, v165
    v_lshlrev_b32 v17, 2, v165
    v_lshlrev_b32 v18, 1, v165
    s_mov_b64 exec, vcc
    ds_write_b32 v17, v73 offset:0
    ds_write_b16 v18, v66 offset:9216
    ds_write_b16_d16_hi v18, v66 offset:13824
    s_mov_b64 exec, -1
    v_cmp_ne_u32 vcc, -1, v68
    v_add_u32 v166, v192, v166
    v_lshlrev_b32 v17, 2, v166
    v_lshlrev_b32 v18, 1, v166
    s_mov_b64 exec, vcc
    ds_write_b32 v17, v74 offset:0
    ds_write_b16 v18, v68 offset:9216
    ds_write_b16_d16_hi v18, v68 offset:13824
    s_mov_b64 exec, -1
    v_cmp_ne_u32 vcc, -1, v70
    v_add_u32 v167, v192, v167
    v_lshlrev_b32 v17, 2, v167
    v_lshlrev_b32 v18, 1, v167
    s_mov_b64 exec, vcc
    ds_write_b32 v17, v75 offset:0
    ds_write_b16 v18, v70 offset:9216
    ds_write_b16_d16_hi v18, v70 offset:13824
    s_mov_b64 exec, -1
    v_cmp_ne_u32 vcc, -1, v65
    s_cbranch_vccz L_plf_4
    v_add3_u32 v168, v192, v168, 16
    v_lshlrev_b32 v17, 2, v168
    v_lshlrev_b32 v18, 1, v168
    s_mov_b64 exec, vcc
    ds_write_b32 v17, v76 offset:0
    ds_write_b16 v18, v65 offset:9216
    ds_write_b16_d16_hi v18, v65 offset:13824
    s_mov_b64 exec, -1
L_plf_4:
    v_cmp_ne_u32 vcc, -1, v67
    s_cbranch_vccz L_plf_5
    v_add3_u32 v169, v192, v169, 16
    v_lshlrev_b32 v17, 2, v169
    v_lshlrev_b32 v18, 1, v169
    s_mov_b64 exec, vcc
    ds_write_b32 v17, v77 offset:0
    ds_write_b16 v18, v67 offset:9216
    ds_write_b16_d16_hi v18, v67 offset:13824
    s_mov_b64 exec, -1
L_plf_5:
    v_cmp_ne_u32 vcc, -1, v69
    s_cbranch_vccz L_plf_6
    v_add3_u32 v170, v192, v170, 16
    v_lshlrev_b32 v17, 2, v170
    v_lshlrev_b32 v18, 1, v170
    s_mov_b64 exec, vcc
    ds_write_b32 v17, v78 offset:0
    ds_write_b16 v18, v69 offset:9216
    ds_write_b16_d16_hi v18, v69 offset:13824
    s_mov_b64 exec, -1
L_plf_6:
    v_cmp_ne_u32 vcc, -1, v71
    s_cbranch_vccz L_plf_7
    v_add3_u32 v171, v192, v171, 16
    v_lshlrev_b32 v17, 2, v171
    v_lshlrev_b32 v18, 1, v171
    s_mov_b64 exec, vcc
    ds_write_b32 v17, v79 offset:0
    ds_write_b16 v18, v71 offset:9216
    ds_write_b16_d16_hi v18, v71 offset:13824
    s_mov_b64 exec, -1
L_plf_7:
L_placed0:
    s_mul_i32 s11, s62, 416
    s_sub_i32 s11, s61, s11
    s_max_i32 s11, s11, 0
    s_min_i32 s11, s11, 416
    s_add_u32 s11, s11, 31
    s_lshr_b32 s60, s11, 5
    s_waitcnt vmcnt(1) lgkmcnt(0)
    s_barrier
L_pipe:
    ds_read_u16 v22, v4 offset:9216
    ds_read_u16 v24, v4 offset:9232
    ds_read_u16 v26, v4 offset:9248
    ds_read_u16 v28, v4 offset:9264
    ds_read_b32 v20, v5 offset:0
    ds_read_u16 v15, v6 offset:13824
    ds_read_u16 v16, v6 offset:13888
    s_waitcnt lgkmcnt(2)
    s_add_u32 m0, s64, 0
    s_nop 0
    buffer_load_dwordx4 v[22:23], s[44:47], 0 idxen offen lds
    s_add_u32 m0, s64, 1024
    s_nop 0
    buffer_load_dwordx4 v[24:25], s[44:47], 0 idxen offen lds
    s_add_u32 m0, s64, 2048
    s_nop 0
    buffer_load_dwordx4 v[26:27], s[44:47], 0 idxen offen lds
    s_add_u32 m0, s64, 3072
    s_nop 0
    buffer_load_dwordx4 v[28:29], s[44:47], 0 idxen offen lds
    buffer_load_dwordx4 v[204:207], v[20:21], s[48:51], 0 idxen offen
    ds_read_u16 v22, v4 offset:9280
    ds_read_u16 v24, v4 offset:9296
    ds_read_u16 v26, v4 offset:9312
    ds_read_u16 v28, v4 offset:9328
    ds_read_b32 v20, v5 offset:128
    s_cmp_lg_u32 s62, 0
    s_cbranch_scc1 L_node_done
    v_add_u32 v17, s70, v2
    v_and_b32 v18, 15, v17
    v_xor_b32 v18, v18, v3
    v_lshlrev_b32 v18, 4, v18
    v_lshl_add_u32 v17, v17, 8, v18
    v_add_u32 v17, 137472, v17
    v_lshl_add_u32 v19, v1, 4, s71
    ds_read_b128 v[152:155], v19 offset:16384
    v_xor_b32 v18, 0, v17
    ds_read_b128 v[80:83], v18
    ds_read_b128 v[164:167], v19 offset:0
    ds_read_b128 v[180:183], v19 offset:8192
    v_xor_b32 v18, 32, v17
    ds_read_b128 v[84:87], v18
    ds_read_b128 v[168:171], v19 offset:1024
    ds_read_b128 v[184:187], v19 offset:9216
    v_xor_b32 v18, 64, v17
    ds_read_b128 v[88:91], v18
    ds_read_b128 v[172:175], v19 offset:2048
    ds_read_b128 v[188:191], v19 offset:10240
    s_waitcnt lgkmcnt(6)
    v_mfma_f32_32x32x16_bf16 v[64:79], v[80:83], v[164:167], 0
    v_mfma_f32_32x32x16_bf16 v[212:227], v[180:183], v[80:83], 0
    v_xor_b32 v18, 96, v17
    ds_read_b128 v[92:95], v18
    ds_read_b128 v[176:179], v19 offset:3072
    ds_read_b128 v[192:195], v19 offset:11264
    s_waitcnt lgkmcnt(6)
    v_mfma_f32_32x32x16_bf16 v[64:79], v[84:87], v[168:171], v[64:79]
    v_mfma_f32_32x32x16_bf16 v[212:227], v[184:187], v[84:87], v[212:227]
    v_xor_b32 v18, 128, v17
    ds_read_b128 v[112:115], v18
    ds_read_b128 v[164:167], v19 offset:4096
    ds_read_b128 v[180:183], v19 offset:12288
    s_waitcnt lgkmcnt(6)
    v_mfma_f32_32x32x16_bf16 v[64:79], v[88:91], v[172:175], v[64:79]
    v_mfma_f32_32x32x16_bf16 v[212:227], v[188:191], v[88:91], v[212:227]
    v_xor_b32 v18, 160, v17
    ds_read_b128 v[116:119], v18
    ds_read_b128 v[168:171], v19 offset:5120
    ds_read_b128 v[184:187], v19 offset:13312
    s_waitcnt lgkmcnt(6)
    v_mfma_f32_32x32x16_bf16 v[64:79], v[92:95], v[176:179], v[64:79]
    v_mfma_f32_32x32x16_bf16 v[212:227], v[192:195], v[92:95], v[212:227]
    v_xor_b32 v18, 192, v17
    ds_read_b128 v[120:123], v18
    ds_read_b128 v[172:175], v19 offset:6144
    ds_read_b128 v[188:191], v19 offset:14336
    s_waitcnt lgkmcnt(6)
    v_mfma_f32_32x32x16_bf16 v[64:79], v[112:115], v[164:167], v[64:79]
    v_mfma_f32_32x32x16_bf16 v[212:227], v[180:183], v[112:115], v[212:227]
    v_xor_b32 v18, 224, v17
    ds_read_b128 v[124:127], v18
    ds_read_b128 v[176:179], v19 offset:7168
    ds_read_b128 v[192:195], v19 offset:15360
    s_waitcnt lgkmcnt(6)
    v_mfma_f32_32x32x16_bf16 v[64:79], v[116:119], v[168:171], v[64:79]
    v_mfma_f32_32x32x16_bf16 v[212:227], v[184:187], v[116:119], v[212:227]
    s_waitcnt lgkmcnt(3)
    v_mfma_f32_32x32x16_bf16 v[64:79], v[120:123], v[172:175], v[64:79]
    v_mfma_f32_32x32x16_bf16 v[212:227], v[188:191], v[120:123], v[212:227]
    s_waitcnt lgkmcnt(0)
    v_mfma_f32_32x32x16_bf16 v[64:79], v[124:127], v[176:179], v[64:79]
    v_mfma_f32_32x32x16_bf16 v[212:227], v[192:195], v[124:127], v[212:227]
    v_mov_b32 v132, 0
    v_mov_b32 v133, 0
    v_mov_b32 v134, 0
    v_mov_b32 v135, 0
    s_nop 1
    v_mfma_f32_32x32x16_bf16 v[32:47], v[132:135], v[132:135], 0
    v_mfma_f32_32x32x16_bf16 v[48:63], v[132:135], v[132:135], 0
    s_nop 2
    v_cvt_pk_bf16_f32 v144, v64, v65
    v_cvt_pk_bf16_f32 v145, v66, v67
    v_cvt_pk_bf16_f32 v146, v68, v69
    v_cvt_pk_bf16_f32 v147, v70, v71
    v_cvt_pk_bf16_f32 v148, v72, v73
    v_cvt_pk_bf16_f32 v149, v74, v75
    v_cvt_pk_bf16_f32 v150, v76, v77
    v_cvt_pk_bf16_f32 v151, v78, v79
L_node_done:
    s_waitcnt lgkmcnt(0)
    s_add_u32 m0, s64, 32768
    s_nop 0
    buffer_load_dwordx4 v[22:23], s[44:47], 0 idxen offen lds
    s_add_u32 m0, s64, 33792
    s_nop 0
    buffer_load_dwordx4 v[24:25], s[44:47], 0 idxen offen lds
    s_add_u32 m0, s64, 34816
    s_nop 0
    buffer_load_dwordx4 v[26:27], s[44:47], 0 idxen offen lds
    s_add_u32 m0, s64, 35840
    s_nop 0
    buffer_load_dwordx4 v[28:29], s[44:47], 0 idxen offen lds
    buffer_load_dwordx4 v[208:211], v[20:21], s[48:51], 0 idxen offen
    ds_read_u16 v22, v4 offset:9344
    ds_read_u16 v24, v4 offset:9360
    ds_read_u16 v26, v4 offset:9376
    ds_read_u16 v28, v4 offset:9392
    ds_read_b32 v20, v5 offset:256
    s_barrier
    s_cmp_eq_u32 s60, 0
    s_cbranch_scc1 L_round_end
    v_mov_b32 v196, 0
    v_mov_b32 v128, 0
    v_mov_b32 v136, 0
    v_mov_b32 v197, 0
    v_mov_b32 v129, 0
    v_mov_b32 v137, 0
    v_mov_b32 v198, 0
    v_mov_b32 v130, 0
    v_mov_b32 v138, 0
    v_mov_b32 v199, 0
    v_mov_b32 v131, 0
    v_mov_b32 v139, 0
    v_mov_b32 v200, 0
    v_mov_b32 v132, 0
    v_mov_b32 v140, 0
    v_mov_b32 v201, 0
    v_mov_b32 v133, 0
    v_mov_b32 v141, 0
    v_mov_b32 v202, 0
    v_mov_b32 v134, 0
    v_mov_b32 v142, 0
    v_mov_b32 v203, 0
    v_mov_b32 v135, 0
    v_mov_b32 v143, 0
    v_bitop3_b32 v15, v15, v240, 62 bitop3:0x28
    v_add_u32 v15, v241, v15
    s_waitcnt vmcnt(5)
    ds_write_b16 v15, v13
    ds_read_b128 v[180:183], v7
    ds_read_b128 v[184:187], v8
    ds_read_b64_tr_b16 v[164:165], v11 offset:0
    ds_read_b64_tr_b16 v[166:167], v11 offset:1024
    ds_read_b64_tr_b16 v[168:169], v11 offset:2048
    ds_read_b64_tr_b16 v[170:171], v11 offset:3072
    ds_read_b64_tr_b16 v[172:173], v12 offset:0
    ds_read_b64_tr_b16 v[174:175], v12 offset:1024
    ds_read_b64_tr_b16 v[176:177], v12 offset:2048
    ds_read_b64_tr_b16 v[178:179], v12 offset:3072
    ds_read_b64_tr_b16 v[188:189], v9 offset:0
    ds_read_b64_tr_b16 v[190:191], v10 offset:512
    ds_read_b64_tr_b16 v[192:193], v9 offset:1024
    ds_read_b64_tr_b16 v[194:195], v10 offset:1536
    ds_write_b16 v15, v14
    v_mfma_f32_32x32x16_bf16 v[64:79], v[204:207], v[152:155], 0
    s_waitcnt lgkmcnt(13)
    v_mfma_f32_32x32x16_bf16 v[64:79], v[180:183], v[144:147], v[64:79]
    v_mfma_f32_32x32x16_bf16 v[64:79], v[184:187], v[148:151], v[64:79]
    s_waitcnt lgkmcnt(9)
    v_smfmac_f32_32x32x32_bf16 v[64:79], v[250:253], v[164:171], v254
    s_waitcnt lgkmcnt(5)
    v_mfma_f32_32x32x16_bf16 v[96:111], v[156:159], v[172:175], 0
    v_mfma_f32_32x32x16_bf16 v[96:111], v[160:163], v[176:179], v[96:111]
    s_mov_b32 s67, s60
    s_cmp_ge_u32 s3, 4
    s_cbranch_scc1 L_follower
    s_mov_b32 s80, 16
    s_waitcnt lgkmcnt(0)
    s_waitcnt vmcnt(0)
    v_bitop3_b32 v16, v16, v240, 62 bitop3:0x28
    v_add_u32 v16, v241, v16
    s_setprio 2
    v_mfma_f32_32x32x16_bf16 v[32:47], v[128:131], v[196:199], v[32:47]
    v_exp_f32 v64, v64
    v_exp_f32 v65, v65
    v_exp_f32 v66, v66
    v_exp_f32 v67, v67
    v_mfma_f32_32x32x16_bf16 v[48:63], v[136:139], v[196:199], v[48:63]
    v_exp_f32 v68, v68
    v_exp_f32 v69, v69
    v_exp_f32 v70, v70
    v_exp_f32 v71, v71
    v_mfma_f32_32x32x16_bf16 v[32:47], v[132:135], v[200:203], v[32:47]
    v_exp_f32 v72, v72
    v_exp_f32 v73, v73
    v_exp_f32 v74, v74
    v_exp_f32 v75, v75
    v_mfma_f32_32x32x16_bf16 v[48:63], v[140:143], v[200:203], v[48:63]
    v_exp_f32 v76, v76
    v_exp_f32 v77, v77
    v_exp_f32 v78, v78
    v_exp_f32 v79, v79
    s_setprio 0
    ds_write_b16 v16, v13
    ds_read_b128 v[180:183], v7
    ds_read_b128 v[184:187], v8
    ds_read_b64_tr_b16 v[164:165], v11 offset:32768
    ds_read_b64_tr_b16 v[166:167], v11 offset:33792
    ds_read_b64_tr_b16 v[168:169], v11 offset:34816
    ds_read_b64_tr_b16 v[170:171], v11 offset:35840
    ds_read_b64_tr_b16 v[172:173], v12 offset:32768
    ds_read_b64_tr_b16 v[174:175], v12 offset:33792
    ds_read_b64_tr_b16 v[176:177], v12 offset:34816
    ds_read_b64_tr_b16 v[178:179], v12 offset:35840
    s_add_u32 m0, s64, 65536
    s_nop 0
    buffer_load_dwordx4 v[22:23], s[44:47], 0 idxen offen lds
    ds_read_u16 v22, v4 offset:9408
    s_add_u32 m0, s64, 66560
    s_nop 0
    buffer_load_dwordx4 v[24:25], s[44:47], 0 idxen offen lds
    ds_read_u16 v24, v4 offset:9424
    s_add_u32 m0, s64, 67584
    s_nop 0
    buffer_load_dwordx4 v[26:27], s[44:47], 0 idxen offen lds
    ds_read_u16 v26, v4 offset:9440
    s_add_u32 m0, s64, 68608
    s_nop 0
    buffer_load_dwordx4 v[28:29], s[44:47], 0 idxen offen lds
    ds_read_u16 v28, v4 offset:9456
    buffer_load_dwordx4 v[244:247], v[20:21], s[48:51], 0 idxen offen
    ds_read_b32 v20, v5 offset:384
    v_add_f32 v64, 1.0, v64
    v_add_f32 v65, 1.0, v65
    v_add_f32 v66, 1.0, v66
    v_add_f32 v67, 1.0, v67
    v_add_f32 v68, 1.0, v68
    v_add_f32 v69, 1.0, v69
    v_add_f32 v70, 1.0, v70
    v_add_f32 v71, 1.0, v71
    v_add_f32 v72, 1.0, v72
    v_add_f32 v73, 1.0, v73
    v_add_f32 v74, 1.0, v74
    v_add_f32 v75, 1.0, v75
    v_add_f32 v76, 1.0, v76
    v_add_f32 v77, 1.0, v77
    v_add_f32 v78, 1.0, v78
    v_add_f32 v79, 1.0, v79
    s_setprio 2
    v_mfma_f32_32x32x16_bf16 v[80:95], v[208:211], v[152:155], 0
    v_rcp_f32 v64, v64
    v_rcp_f32 v65, v65
    v_rcp_f32 v66, v66
    s_waitcnt lgkmcnt(14)
    v_mfma_f32_32x32x16_bf16 v[80:95], v[180:183], v[144:147], v[80:95]
    v_rcp_f32 v67, v67
    v_rcp_f32 v68, v68
    v_rcp_f32 v69, v69
    s_waitcnt lgkmcnt(13)
    v_mfma_f32_32x32x16_bf16 v[80:95], v[184:187], v[148:151], v[80:95]
    v_rcp_f32 v70, v70
    v_rcp_f32 v71, v71
    v_rcp_f32 v72, v72
    v_rcp_f32 v73, v73
    s_waitcnt lgkmcnt(9)
    v_smfmac_f32_32x32x32_bf16 v[80:95], v[250:253], v[164:171], v254
    v_rcp_f32 v74, v74
    v_rcp_f32 v75, v75
    v_rcp_f32 v76, v76
    v_rcp_f32 v77, v77
    v_rcp_f32 v78, v78
    v_rcp_f32 v79, v79
    s_setprio 0
    ds_read_b64_tr_b16 v[196:197], v9 offset:0
    ds_read_b64_tr_b16 v[198:199], v10 offset:512
    ds_read_b64_tr_b16 v[200:201], v9 offset:1024
    ds_read_b64_tr_b16 v[202:203], v10 offset:1536
    ds_write_b16 v16, v14
    s_waitcnt lgkmcnt(9)
    s_add_u32 m0, s64, 0
    s_nop 0
    buffer_load_dwordx4 v[22:23], s[44:47], 0 idxen offen lds
    ds_read_u16 v22, v4 offset:9472
    s_waitcnt lgkmcnt(9)
    s_add_u32 m0, s64, 1024
    s_nop 0
    buffer_load_dwordx4 v[24:25], s[44:47], 0 idxen offen lds
    ds_read_u16 v24, v4 offset:9488
    s_waitcnt lgkmcnt(9)
    s_add_u32 m0, s64, 2048
    s_nop 0
    buffer_load_dwordx4 v[26:27], s[44:47], 0 idxen offen lds
    ds_read_u16 v26, v4 offset:9504
    s_waitcnt lgkmcnt(9)
    s_add_u32 m0, s64, 3072
    s_nop 0
    buffer_load_dwordx4 v[28:29], s[44:47], 0 idxen offen lds
    ds_read_u16 v28, v4 offset:9520
    s_waitcnt lgkmcnt(9)
    buffer_load_dwordx4 v[204:207], v[20:21], s[48:51], 0 idxen offen
    ds_read_b32 v20, v5 offset:512
    ds_read_u16 v15, v6 offset:13952
    v_mul_f32 v96, v64, v96
    v_mul_f32 v97, v65, v97
    v_mul_f32 v98, v66, v98
    v_mul_f32 v99, v67, v99
    v_mul_f32 v100, v68, v100
    v_mul_f32 v101, v69, v101
    v_mul_f32 v102, v70, v102
    v_mul_f32 v103, v71, v103
    v_mul_f32 v104, v72, v104
    v_mul_f32 v105, v73, v105
    v_mul_f32 v106, v74, v106
    v_mul_f32 v107, v75, v107
    v_mul_f32 v108, v76, v108
    v_mul_f32 v109, v77, v109
    v_mul_f32 v110, v78, v110
    v_mul_f32 v111, v79, v111
    s_setprio 2
    v_cvt_pk_bf16_f32 v128, v64, v65
    v_cvt_pk_bf16_f32 v136, v96, v97
    v_cvt_pk_bf16_f32 v129, v66, v67
    v_cvt_pk_bf16_f32 v137, v98, v99
    s_waitcnt lgkmcnt(15)
    v_mfma_f32_32x32x16_bf16 v[112:127], v[156:159], v[172:175], 0
    v_cvt_pk_bf16_f32 v130, v68, v69
    v_cvt_pk_bf16_f32 v138, v100, v101
    v_cvt_pk_bf16_f32 v131, v70, v71
    v_cvt_pk_bf16_f32 v139, v102, v103
    v_cvt_pk_bf16_f32 v132, v72, v73
    v_cvt_pk_bf16_f32 v140, v104, v105
    v_cvt_pk_bf16_f32 v133, v74, v75
    v_cvt_pk_bf16_f32 v141, v106, v107
    s_waitcnt lgkmcnt(15)
    v_mfma_f32_32x32x16_bf16 v[112:127], v[160:163], v[176:179], v[112:127]
    v_cvt_pk_bf16_f32 v134, v76, v77
    v_cvt_pk_bf16_f32 v142, v108, v109
    v_cvt_pk_bf16_f32 v135, v78, v79
    v_cvt_pk_bf16_f32 v143, v110, v111
    s_sub_u32 s67, s67, 1
    s_cmp_eq_u32 s67, 0
    s_cbranch_scc1 L_exit0
L_loop:
    s_waitcnt lgkmcnt(0)
    s_waitcnt vmcnt(5)
    v_bitop3_b32 v15, v15, v240, 62 bitop3:0x28
    v_add_u32 v15, v241, v15
    s_setprio 2
    v_mfma_f32_32x32x16_bf16 v[32:47], v[128:131], v[188:191], v[32:47]
    v_exp_f32 v80, v80
    v_exp_f32 v81, v81
    v_exp_f32 v82, v82
    v_exp_f32 v83, v83
    v_mfma_f32_32x32x16_bf16 v[48:63], v[136:139], v[188:191], v[48:63]
    v_exp_f32 v84, v84
    v_exp_f32 v85, v85
    v_exp_f32 v86, v86
    v_exp_f32 v87, v87
    v_mfma_f32_32x32x16_bf16 v[32:47], v[132:135], v[192:195], v[32:47]
    v_exp_f32 v88, v88
    v_exp_f32 v89, v89
    v_exp_f32 v90, v90
    v_exp_f32 v91, v91
    v_mfma_f32_32x32x16_bf16 v[48:63], v[140:143], v[192:195], v[48:63]
    v_exp_f32 v92, v92
    v_exp_f32 v93, v93
    v_exp_f32 v94, v94
    v_exp_f32 v95, v95
    s_setprio 0
    ds_write_b16 v15, v13
    ds_read_b128 v[180:183], v7
    ds_read_b128 v[184:187], v8
    ds_read_b64_tr_b16 v[164:165], v248 offset:0
    ds_read_b64_tr_b16 v[166:167], v248 offset:1024
    ds_read_b64_tr_b16 v[168:169], v248 offset:2048
    ds_read_b64_tr_b16 v[170:171], v248 offset:3072
    ds_read_b64_tr_b16 v[172:173], v249 offset:0
    ds_read_b64_tr_b16 v[174:175], v249 offset:1024
    s_add_u32 m0, s64, 32768
    ds_read_b64_tr_b16 v[176:177], v249 offset:2048
    buffer_load_dwordx4 v[22:23], s[44:47], 0 idxen offen lds
    ds_read_u16 v22, v4 offset:9536
    s_add_u32 m0, s64, 33792
    ds_read_b64_tr_b16 v[178:179], v249 offset:3072
    buffer_load_dwordx4 v[24:25], s[44:47], 0 idxen offen lds
    ds_read_u16 v24, v4 offset:9552
    v_add_f32 v80, 1.0, v80
    v_add_f32 v81, 1.0, v81
    v_add_f32 v82, 1.0, v82
    v_add_f32 v83, 1.0, v83
    v_add_f32 v84, 1.0, v84
    v_add_f32 v85, 1.0, v85
    v_add_f32 v86, 1.0, v86
    v_add_f32 v87, 1.0, v87
    v_add_f32 v88, 1.0, v88
    v_add_f32 v89, 1.0, v89
    v_add_f32 v90, 1.0, v90
    v_add_f32 v91, 1.0, v91
    v_add_f32 v92, 1.0, v92
    v_add_f32 v93, 1.0, v93
    v_add_f32 v94, 1.0, v94
    v_add_f32 v95, 1.0, v95
    s_setprio 2
    v_mfma_f32_32x32x16_bf16 v[64:79], v[244:247], v[152:155], 0
    v_rcp_f32 v80, v80
    v_rcp_f32 v81, v81
    v_rcp_f32 v82, v82
    s_waitcnt lgkmcnt(11)
    v_mfma_f32_32x32x16_bf16 v[64:79], v[180:183], v[144:147], v[64:79]
    v_rcp_f32 v83, v83
    v_rcp_f32 v84, v84
    v_rcp_f32 v85, v85
    s_waitcnt lgkmcnt(10)
    v_mfma_f32_32x32x16_bf16 v[64:79], v[184:187], v[148:151], v[64:79]
    v_rcp_f32 v86, v86
    v_rcp_f32 v87, v87
    v_rcp_f32 v88, v88
    v_rcp_f32 v89, v89
    s_waitcnt lgkmcnt(6)
    v_smfmac_f32_32x32x32_bf16 v[64:79], v[250:253], v[164:171], v254
    v_rcp_f32 v90, v90
    v_rcp_f32 v91, v91
    v_rcp_f32 v92, v92
    v_rcp_f32 v93, v93
    v_rcp_f32 v94, v94
    v_rcp_f32 v95, v95
    s_setprio 0
    ds_read_b64_tr_b16 v[188:189], v9 offset:0
    ds_read_b64_tr_b16 v[190:191], v10 offset:512
    ds_read_b64_tr_b16 v[192:193], v9 offset:1024
    s_add_u32 m0, s64, 34816
    ds_read_b64_tr_b16 v[194:195], v10 offset:1536
    buffer_load_dwordx4 v[26:27], s[44:47], 0 idxen offen lds
    ds_read_u16 v26, v4 offset:9568
    s_add_u32 m0, s64, 35840
    ds_write_b16 v15, v14
    buffer_load_dwordx4 v[28:29], s[44:47], 0 idxen offen lds
    ds_read_u16 v28, v4 offset:9584
    buffer_load_dwordx4 v[208:211], v[20:21], s[48:51], 0 idxen offen
    ds_read_b32 v20, v5 offset:640
    ds_read_u16 v16, v6 offset:14016
    v_mul_f32 v112, v80, v112
    v_mul_f32 v113, v81, v113
    v_mul_f32 v114, v82, v114
    v_mul_f32 v115, v83, v115
    v_mul_f32 v116, v84, v116
    v_mul_f32 v117, v85, v117
    v_mul_f32 v118, v86, v118
    v_mul_f32 v119, v87, v119
    v_mul_f32 v120, v88, v120
    v_mul_f32 v121, v89, v121
    v_mul_f32 v122, v90, v122
    v_mul_f32 v123, v91, v123
    v_mul_f32 v124, v92, v124
    v_mul_f32 v125, v93, v125
    v_mul_f32 v126, v94, v126
    v_mul_f32 v127, v95, v127
    s_setprio 2
    v_cvt_pk_bf16_f32 v128, v80, v81
    v_cvt_pk_bf16_f32 v136, v112, v113
    v_cvt_pk_bf16_f32 v129, v82, v83
    v_cvt_pk_bf16_f32 v137, v114, v115
    s_waitcnt lgkmcnt(13)
    v_mfma_f32_32x32x16_bf16 v[96:111], v[156:159], v[172:175], 0
    v_cvt_pk_bf16_f32 v130, v84, v85
    v_cvt_pk_bf16_f32 v138, v116, v117
    v_cvt_pk_bf16_f32 v131, v86, v87
    v_cvt_pk_bf16_f32 v139, v118, v119
    v_cvt_pk_bf16_f32 v132, v88, v89
    v_cvt_pk_bf16_f32 v140, v120, v121
    v_cvt_pk_bf16_f32 v133, v90, v91
    v_cvt_pk_bf16_f32 v141, v122, v123
    s_waitcnt lgkmcnt(10)
    v_mfma_f32_32x32x16_bf16 v[96:111], v[160:163], v[176:179], v[96:111]
    v_cvt_pk_bf16_f32 v134, v92, v93
    v_cvt_pk_bf16_f32 v142, v124, v125
    v_cvt_pk_bf16_f32 v135, v94, v95
    v_cvt_pk_bf16_f32 v143, v126, v127
    s_sub_u32 s67, s67, 1
    s_cmp_eq_u32 s67, 0
    s_cbranch_scc1 L_exit1
    s_waitcnt lgkmcnt(0)
    s_waitcnt vmcnt(5)
    v_bitop3_b32 v16, v16, v240, 62 bitop3:0x28
    v_add_u32 v16, v241, v16
    s_setprio 2
    v_mfma_f32_32x32x16_bf16 v[32:47], v[128:131], v[196:199], v[32:47]
    v_exp_f32 v64, v64
    v_exp_f32 v65, v65
    v_exp_f32 v66, v66
    v_exp_f32 v67, v67
    v_mfma_f32_32x32x16_bf16 v[48:63], v[136:139], v[196:199], v[48:63]
    v_exp_f32 v68, v68
    v_exp_f32 v69, v69
    v_exp_f32 v70, v70
    v_exp_f32 v71, v71
    v_mfma_f32_32x32x16_bf16 v[32:47], v[132:135], v[200:203], v[32:47]
    v_exp_f32 v72, v72
    v_exp_f32 v73, v73
    v_exp_f32 v74, v74
    v_exp_f32 v75, v75
    v_mfma_f32_32x32x16_bf16 v[48:63], v[140:143], v[200:203], v[48:63]
    v_exp_f32 v76, v76
    v_exp_f32 v77, v77
    v_exp_f32 v78, v78
    v_exp_f32 v79, v79
    s_setprio 0
    ds_write_b16 v16, v13
    ds_read_b128 v[180:183], v7
    ds_read_b128 v[184:187], v8
    ds_read_b64_tr_b16 v[164:165], v11 offset:0
    ds_read_b64_tr_b16 v[166:167], v11 offset:1024
    ds_read_b64_tr_b16 v[168:169], v11 offset:2048
    ds_read_b64_tr_b16 v[170:171], v11 offset:3072
    ds_read_b64_tr_b16 v[172:173], v12 offset:0
    ds_read_b64_tr_b16 v[174:175], v12 offset:1024
    s_add_u32 m0, s64, 65536
    ds_read_b64_tr_b16 v[176:177], v12 offset:2048
    buffer_load_dwordx4 v[22:23], s[44:47], 0 idxen offen lds
    ds_read_u16 v22, v4 offset:9600
    s_add_u32 m0, s64, 66560
    ds_read_b64_tr_b16 v[178:179], v12 offset:3072
    buffer_load_dwordx4 v[24:25], s[44:47], 0 idxen offen lds
    ds_read_u16 v24, v4 offset:9616
    v_add_f32 v64, 1.0, v64
    v_add_f32 v65, 1.0, v65
    v_add_f32 v66, 1.0, v66
    v_add_f32 v67, 1.0, v67
    v_add_f32 v68, 1.0, v68
    v_add_f32 v69, 1.0, v69
    v_add_f32 v70, 1.0, v70
    v_add_f32 v71, 1.0, v71
    v_add_f32 v72, 1.0, v72
    v_add_f32 v73, 1.0, v73
    v_add_f32 v74, 1.0, v74
    v_add_f32 v75, 1.0, v75
    v_add_f32 v76, 1.0, v76
    v_add_f32 v77, 1.0, v77
    v_add_f32 v78, 1.0, v78
    v_add_f32 v79, 1.0, v79
    s_setprio 2
    v_mfma_f32_32x32x16_bf16 v[80:95], v[204:207], v[152:155], 0
    v_rcp_f32 v64, v64
    v_rcp_f32 v65, v65
    v_rcp_f32 v66, v66
    s_waitcnt lgkmcnt(11)
    v_mfma_f32_32x32x16_bf16 v[80:95], v[180:183], v[144:147], v[80:95]
    v_rcp_f32 v67, v67
    v_rcp_f32 v68, v68
    v_rcp_f32 v69, v69
    s_waitcnt lgkmcnt(10)
    v_mfma_f32_32x32x16_bf16 v[80:95], v[184:187], v[148:151], v[80:95]
    v_rcp_f32 v70, v70
    v_rcp_f32 v71, v71
    v_rcp_f32 v72, v72
    v_rcp_f32 v73, v73
    s_waitcnt lgkmcnt(6)
    v_smfmac_f32_32x32x32_bf16 v[80:95], v[250:253], v[164:171], v254
    v_rcp_f32 v74, v74
    v_rcp_f32 v75, v75
    v_rcp_f32 v76, v76
    v_rcp_f32 v77, v77
    v_rcp_f32 v78, v78
    v_rcp_f32 v79, v79
    s_setprio 0
    ds_read_b64_tr_b16 v[196:197], v9 offset:0
    ds_read_b64_tr_b16 v[198:199], v10 offset:512
    ds_read_b64_tr_b16 v[200:201], v9 offset:1024
    s_add_u32 m0, s64, 67584
    ds_read_b64_tr_b16 v[202:203], v10 offset:1536
    buffer_load_dwordx4 v[26:27], s[44:47], 0 idxen offen lds
    ds_read_u16 v26, v4 offset:9632
    s_add_u32 m0, s64, 68608
    ds_write_b16 v16, v14
    buffer_load_dwordx4 v[28:29], s[44:47], 0 idxen offen lds
    ds_read_u16 v28, v4 offset:9648
    buffer_load_dwordx4 v[244:247], v[20:21], s[48:51], 0 idxen offen
    ds_read_b32 v20, v5 offset:768
    ds_read_u16 v15, v6 offset:14080
    v_mul_f32 v96, v64, v96
    v_mul_f32 v97, v65, v97
    v_mul_f32 v98, v66, v98
    v_mul_f32 v99, v67, v99
    v_mul_f32 v100, v68, v100
    v_mul_f32 v101, v69, v101
    v_mul_f32 v102, v70, v102
    v_mul_f32 v103, v71, v103
    v_mul_f32 v104, v72, v104
    v_mul_f32 v105, v73, v105
    v_mul_f32 v106, v74, v106
    v_mul_f32 v107, v75, v107
    v_mul_f32 v108, v76, v108
    v_mul_f32 v109, v77, v109
    v_mul_f32 v110, v78, v110
    v_mul_f32 v111, v79, v111
    s_setprio 2
    v_cvt_pk_bf16_f32 v128, v64, v65
    v_cvt_pk_bf16_f32 v136, v96, v97
    v_cvt_pk_bf16_f32 v129, v66, v67
    v_cvt_pk_bf16_f32 v137, v98, v99
    s_waitcnt lgkmcnt(13)
    v_mfma_f32_32x32x16_bf16 v[112:127], v[156:159], v[172:175], 0
    v_cvt_pk_bf16_f32 v130, v68, v69
    v_cvt_pk_bf16_f32 v138, v100, v101
    v_cvt_pk_bf16_f32 v131, v70, v71
    v_cvt_pk_bf16_f32 v139, v102, v103
    v_cvt_pk_bf16_f32 v132, v72, v73
    v_cvt_pk_bf16_f32 v140, v104, v105
    v_cvt_pk_bf16_f32 v133, v74, v75
    v_cvt_pk_bf16_f32 v141, v106, v107
    s_waitcnt lgkmcnt(10)
    v_mfma_f32_32x32x16_bf16 v[112:127], v[160:163], v[176:179], v[112:127]
    v_cvt_pk_bf16_f32 v134, v76, v77
    v_cvt_pk_bf16_f32 v142, v108, v109
    v_cvt_pk_bf16_f32 v135, v78, v79
    v_cvt_pk_bf16_f32 v143, v110, v111
    s_sub_u32 s67, s67, 1
    s_cmp_eq_u32 s67, 0
    s_cbranch_scc1 L_exit0
    s_waitcnt lgkmcnt(0)
    s_waitcnt vmcnt(5)
    v_bitop3_b32 v15, v15, v240, 62 bitop3:0x28
    v_add_u32 v15, v241, v15
    s_setprio 2
    v_mfma_f32_32x32x16_bf16 v[32:47], v[128:131], v[188:191], v[32:47]
    v_exp_f32 v80, v80
    v_exp_f32 v81, v81
    v_exp_f32 v82, v82
    v_exp_f32 v83, v83
    v_mfma_f32_32x32x16_bf16 v[48:63], v[136:139], v[188:191], v[48:63]
    v_exp_f32 v84, v84
    v_exp_f32 v85, v85
    v_exp_f32 v86, v86
    v_exp_f32 v87, v87
    v_mfma_f32_32x32x16_bf16 v[32:47], v[132:135], v[192:195], v[32:47]
    v_exp_f32 v88, v88
    v_exp_f32 v89, v89
    v_exp_f32 v90, v90
    v_exp_f32 v91, v91
    v_mfma_f32_32x32x16_bf16 v[48:63], v[140:143], v[192:195], v[48:63]
    v_exp_f32 v92, v92
    v_exp_f32 v93, v93
    v_exp_f32 v94, v94
    v_exp_f32 v95, v95
    s_setprio 0
    ds_write_b16 v15, v13
    ds_read_b128 v[180:183], v7
    ds_read_b128 v[184:187], v8
    ds_read_b64_tr_b16 v[164:165], v11 offset:32768
    ds_read_b64_tr_b16 v[166:167], v11 offset:33792
    ds_read_b64_tr_b16 v[168:169], v11 offset:34816
    ds_read_b64_tr_b16 v[170:171], v11 offset:35840
    ds_read_b64_tr_b16 v[172:173], v12 offset:32768
    ds_read_b64_tr_b16 v[174:175], v12 offset:33792
    s_add_u32 m0, s64, 0
    ds_read_b64_tr_b16 v[176:177], v12 offset:34816
    buffer_load_dwordx4 v[22:23], s[44:47], 0 idxen offen lds
    ds_read_u16 v22, v4 offset:9664
    s_add_u32 m0, s64, 1024
    ds_read_b64_tr_b16 v[178:179], v12 offset:35840
    buffer_load_dwordx4 v[24:25], s[44:47], 0 idxen offen lds
    ds_read_u16 v24, v4 offset:9680
    v_add_f32 v80, 1.0, v80
    v_add_f32 v81, 1.0, v81
    v_add_f32 v82, 1.0, v82
    v_add_f32 v83, 1.0, v83
    v_add_f32 v84, 1.0, v84
    v_add_f32 v85, 1.0, v85
    v_add_f32 v86, 1.0, v86
    v_add_f32 v87, 1.0, v87
    v_add_f32 v88, 1.0, v88
    v_add_f32 v89, 1.0, v89
    v_add_f32 v90, 1.0, v90
    v_add_f32 v91, 1.0, v91
    v_add_f32 v92, 1.0, v92
    v_add_f32 v93, 1.0, v93
    v_add_f32 v94, 1.0, v94
    v_add_f32 v95, 1.0, v95
    s_setprio 2
    v_mfma_f32_32x32x16_bf16 v[64:79], v[208:211], v[152:155], 0
    v_rcp_f32 v80, v80
    v_rcp_f32 v81, v81
    v_rcp_f32 v82, v82
    s_waitcnt lgkmcnt(11)
    v_mfma_f32_32x32x16_bf16 v[64:79], v[180:183], v[144:147], v[64:79]
    v_rcp_f32 v83, v83
    v_rcp_f32 v84, v84
    v_rcp_f32 v85, v85
    s_waitcnt lgkmcnt(10)
    v_mfma_f32_32x32x16_bf16 v[64:79], v[184:187], v[148:151], v[64:79]
    v_rcp_f32 v86, v86
    v_rcp_f32 v87, v87
    v_rcp_f32 v88, v88
    v_rcp_f32 v89, v89
    s_waitcnt lgkmcnt(6)
    v_smfmac_f32_32x32x32_bf16 v[64:79], v[250:253], v[164:171], v254
    v_rcp_f32 v90, v90
    v_rcp_f32 v91, v91
    v_rcp_f32 v92, v92
    v_rcp_f32 v93, v93
    v_rcp_f32 v94, v94
    v_rcp_f32 v95, v95
    s_setprio 0
    ds_read_b64_tr_b16 v[188:189], v9 offset:0
    ds_read_b64_tr_b16 v[190:191], v10 offset:512
    ds_read_b64_tr_b16 v[192:193], v9 offset:1024
    s_add_u32 m0, s64, 2048
    ds_read_b64_tr_b16 v[194:195], v10 offset:1536
    buffer_load_dwordx4 v[26:27], s[44:47], 0 idxen offen lds
    ds_read_u16 v26, v4 offset:9696
    s_add_u32 m0, s64, 3072
    ds_write_b16 v15, v14
    buffer_load_dwordx4 v[28:29], s[44:47], 0 idxen offen lds
    ds_read_u16 v28, v4 offset:9712
    buffer_load_dwordx4 v[204:207], v[20:21], s[48:51], 0 idxen offen
    ds_read_b32 v20, v5 offset:896
    ds_read_u16 v16, v6 offset:14144
    v_mul_f32 v112, v80, v112
    v_mul_f32 v113, v81, v113
    v_mul_f32 v114, v82, v114
    v_mul_f32 v115, v83, v115
    v_mul_f32 v116, v84, v116
    v_mul_f32 v117, v85, v117
    v_mul_f32 v118, v86, v118
    v_mul_f32 v119, v87, v119
    v_mul_f32 v120, v88, v120
    v_mul_f32 v121, v89, v121
    v_mul_f32 v122, v90, v122
    v_mul_f32 v123, v91, v123
    v_mul_f32 v124, v92, v124
    v_mul_f32 v125, v93, v125
    v_mul_f32 v126, v94, v126
    v_mul_f32 v127, v95, v127
    s_setprio 2
    v_cvt_pk_bf16_f32 v128, v80, v81
    v_cvt_pk_bf16_f32 v136, v112, v113
    v_cvt_pk_bf16_f32 v129, v82, v83
    v_cvt_pk_bf16_f32 v137, v114, v115
    s_waitcnt lgkmcnt(13)
    v_mfma_f32_32x32x16_bf16 v[96:111], v[156:159], v[172:175], 0
    v_cvt_pk_bf16_f32 v130, v84, v85
    v_cvt_pk_bf16_f32 v138, v116, v117
    v_cvt_pk_bf16_f32 v131, v86, v87
    v_cvt_pk_bf16_f32 v139, v118, v119
    v_cvt_pk_bf16_f32 v132, v88, v89
    v_cvt_pk_bf16_f32 v140, v120, v121
    v_cvt_pk_bf16_f32 v133, v90, v91
    v_cvt_pk_bf16_f32 v141, v122, v123
    s_waitcnt lgkmcnt(10)
    v_mfma_f32_32x32x16_bf16 v[96:111], v[160:163], v[176:179], v[96:111]
    v_cvt_pk_bf16_f32 v134, v92, v93
    v_cvt_pk_bf16_f32 v142, v124, v125
    v_cvt_pk_bf16_f32 v135, v94, v95
    v_cvt_pk_bf16_f32 v143, v126, v127
    s_sub_u32 s67, s67, 1
    s_cmp_eq_u32 s67, 0
    s_cbranch_scc1 L_exit1
    s_waitcnt lgkmcnt(0)
    s_waitcnt vmcnt(5)
    v_bitop3_b32 v16, v16, v240, 62 bitop3:0x28
    v_add_u32 v16, v241, v16
    s_setprio 2
    v_mfma_f32_32x32x16_bf16 v[32:47], v[128:131], v[196:199], v[32:47]
    v_exp_f32 v64, v64
    v_exp_f32 v65, v65
    v_exp_f32 v66, v66
    v_exp_f32 v67, v67
    v_mfma_f32_32x32x16_bf16 v[48:63], v[136:139], v[196:199], v[48:63]
    v_exp_f32 v68, v68
    v_exp_f32 v69, v69
    v_exp_f32 v70, v70
    v_exp_f32 v71, v71
    v_mfma_f32_32x32x16_bf16 v[32:47], v[132:135], v[200:203], v[32:47]
    v_exp_f32 v72, v72
    v_exp_f32 v73, v73
    v_exp_f32 v74, v74
    v_exp_f32 v75, v75
    v_mfma_f32_32x32x16_bf16 v[48:63], v[140:143], v[200:203], v[48:63]
    v_exp_f32 v76, v76
    v_exp_f32 v77, v77
    v_exp_f32 v78, v78
    v_exp_f32 v79, v79
    s_setprio 0
    ds_write_b16 v16, v13
    ds_read_b128 v[180:183], v7
    ds_read_b128 v[184:187], v8
    ds_read_b64_tr_b16 v[164:165], v248 offset:0
    ds_read_b64_tr_b16 v[166:167], v248 offset:1024
    ds_read_b64_tr_b16 v[168:169], v248 offset:2048
    ds_read_b64_tr_b16 v[170:171], v248 offset:3072
    ds_read_b64_tr_b16 v[172:173], v249 offset:0
    ds_read_b64_tr_b16 v[174:175], v249 offset:1024
    s_add_u32 m0, s64, 32768
    ds_read_b64_tr_b16 v[176:177], v249 offset:2048
    buffer_load_dwordx4 v[22:23], s[44:47], 0 idxen offen lds
    ds_read_u16 v22, v4 offset:9728
    s_add_u32 m0, s64, 33792
    ds_read_b64_tr_b16 v[178:179], v249 offset:3072
    buffer_load_dwordx4 v[24:25], s[44:47], 0 idxen offen lds
    ds_read_u16 v24, v4 offset:9744
    v_add_f32 v64, 1.0, v64
    v_add_f32 v65, 1.0, v65
    v_add_f32 v66, 1.0, v66
    v_add_f32 v67, 1.0, v67
    v_add_f32 v68, 1.0, v68
    v_add_f32 v69, 1.0, v69
    v_add_f32 v70, 1.0, v70
    v_add_f32 v71, 1.0, v71
    v_add_f32 v72, 1.0, v72
    v_add_f32 v73, 1.0, v73
    v_add_f32 v74, 1.0, v74
    v_add_f32 v75, 1.0, v75
    v_add_f32 v76, 1.0, v76
    v_add_f32 v77, 1.0, v77
    v_add_f32 v78, 1.0, v78
    v_add_f32 v79, 1.0, v79
    s_setprio 2
    v_mfma_f32_32x32x16_bf16 v[80:95], v[244:247], v[152:155], 0
    v_rcp_f32 v64, v64
    v_rcp_f32 v65, v65
    v_rcp_f32 v66, v66
    s_waitcnt lgkmcnt(11)
    v_mfma_f32_32x32x16_bf16 v[80:95], v[180:183], v[144:147], v[80:95]
    v_rcp_f32 v67, v67
    v_rcp_f32 v68, v68
    v_rcp_f32 v69, v69
    s_waitcnt lgkmcnt(10)
    v_mfma_f32_32x32x16_bf16 v[80:95], v[184:187], v[148:151], v[80:95]
    v_rcp_f32 v70, v70
    v_rcp_f32 v71, v71
    v_rcp_f32 v72, v72
    v_rcp_f32 v73, v73
    s_waitcnt lgkmcnt(6)
    v_smfmac_f32_32x32x32_bf16 v[80:95], v[250:253], v[164:171], v254
    v_rcp_f32 v74, v74
    v_rcp_f32 v75, v75
    v_rcp_f32 v76, v76
    v_rcp_f32 v77, v77
    v_rcp_f32 v78, v78
    v_rcp_f32 v79, v79
    s_setprio 0
    ds_read_b64_tr_b16 v[196:197], v9 offset:0
    ds_read_b64_tr_b16 v[198:199], v10 offset:512
    ds_read_b64_tr_b16 v[200:201], v9 offset:1024
    s_add_u32 m0, s64, 34816
    ds_read_b64_tr_b16 v[202:203], v10 offset:1536
    buffer_load_dwordx4 v[26:27], s[44:47], 0 idxen offen lds
    ds_read_u16 v26, v4 offset:9760
    s_add_u32 m0, s64, 35840
    ds_write_b16 v16, v14
    buffer_load_dwordx4 v[28:29], s[44:47], 0 idxen offen lds
    ds_read_u16 v28, v4 offset:9776
    buffer_load_dwordx4 v[208:211], v[20:21], s[48:51], 0 idxen offen
    ds_read_b32 v20, v5 offset:1024
    ds_read_u16 v15, v6 offset:14208
    v_mul_f32 v96, v64, v96
    v_mul_f32 v97, v65, v97
    v_mul_f32 v98, v66, v98
    v_mul_f32 v99, v67, v99
    v_mul_f32 v100, v68, v100
    v_mul_f32 v101, v69, v101
    v_mul_f32 v102, v70, v102
    v_mul_f32 v103, v71, v103
    v_mul_f32 v104, v72, v104
    v_mul_f32 v105, v73, v105
    v_mul_f32 v106, v74, v106
    v_mul_f32 v107, v75, v107
    v_mul_f32 v108, v76, v108
    v_mul_f32 v109, v77, v109
    v_mul_f32 v110, v78, v110
    v_mul_f32 v111, v79, v111
    s_setprio 2
    v_cvt_pk_bf16_f32 v128, v64, v65
    v_cvt_pk_bf16_f32 v136, v96, v97
    v_cvt_pk_bf16_f32 v129, v66, v67
    v_cvt_pk_bf16_f32 v137, v98, v99
    s_waitcnt lgkmcnt(13)
    v_mfma_f32_32x32x16_bf16 v[112:127], v[156:159], v[172:175], 0
    v_cvt_pk_bf16_f32 v130, v68, v69
    v_cvt_pk_bf16_f32 v138, v100, v101
    v_cvt_pk_bf16_f32 v131, v70, v71
    v_cvt_pk_bf16_f32 v139, v102, v103
    v_cvt_pk_bf16_f32 v132, v72, v73
    v_cvt_pk_bf16_f32 v140, v104, v105
    v_cvt_pk_bf16_f32 v133, v74, v75
    v_cvt_pk_bf16_f32 v141, v106, v107
    s_waitcnt lgkmcnt(10)
    v_mfma_f32_32x32x16_bf16 v[112:127], v[160:163], v[176:179], v[112:127]
    v_cvt_pk_bf16_f32 v134, v76, v77
    v_cvt_pk_bf16_f32 v142, v108, v109
    v_cvt_pk_bf16_f32 v135, v78, v79
    v_cvt_pk_bf16_f32 v143, v110, v111
    s_sub_u32 s67, s67, 1
    s_cmp_eq_u32 s67, 0
    s_cbranch_scc1 L_exit0
    s_waitcnt lgkmcnt(0)
    s_waitcnt vmcnt(5)
    v_bitop3_b32 v15, v15, v240, 62 bitop3:0x28
    v_add_u32 v15, v241, v15
    s_setprio 2
    v_mfma_f32_32x32x16_bf16 v[32:47], v[128:131], v[188:191], v[32:47]
    v_exp_f32 v80, v80
    v_exp_f32 v81, v81
    v_exp_f32 v82, v82
    v_exp_f32 v83, v83
    v_mfma_f32_32x32x16_bf16 v[48:63], v[136:139], v[188:191], v[48:63]
    v_exp_f32 v84, v84
    v_exp_f32 v85, v85
    v_exp_f32 v86, v86
    v_exp_f32 v87, v87
    v_mfma_f32_32x32x16_bf16 v[32:47], v[132:135], v[192:195], v[32:47]
    v_exp_f32 v88, v88
    v_exp_f32 v89, v89
    v_exp_f32 v90, v90
    v_exp_f32 v91, v91
    v_mfma_f32_32x32x16_bf16 v[48:63], v[140:143], v[192:195], v[48:63]
    v_exp_f32 v92, v92
    v_exp_f32 v93, v93
    v_exp_f32 v94, v94
    v_exp_f32 v95, v95
    s_setprio 0
    ds_write_b16 v15, v13
    ds_read_b128 v[180:183], v7
    ds_read_b128 v[184:187], v8
    ds_read_b64_tr_b16 v[164:165], v11 offset:0
    ds_read_b64_tr_b16 v[166:167], v11 offset:1024
    ds_read_b64_tr_b16 v[168:169], v11 offset:2048
    ds_read_b64_tr_b16 v[170:171], v11 offset:3072
    ds_read_b64_tr_b16 v[172:173], v12 offset:0
    ds_read_b64_tr_b16 v[174:175], v12 offset:1024
    s_add_u32 m0, s64, 65536
    ds_read_b64_tr_b16 v[176:177], v12 offset:2048
    buffer_load_dwordx4 v[22:23], s[44:47], 0 idxen offen lds
    ds_read_u16 v22, v4 offset:9792
    s_add_u32 m0, s64, 66560
    ds_read_b64_tr_b16 v[178:179], v12 offset:3072
    buffer_load_dwordx4 v[24:25], s[44:47], 0 idxen offen lds
    ds_read_u16 v24, v4 offset:9808
    v_add_f32 v80, 1.0, v80
    v_add_f32 v81, 1.0, v81
    v_add_f32 v82, 1.0, v82
    v_add_f32 v83, 1.0, v83
    v_add_f32 v84, 1.0, v84
    v_add_f32 v85, 1.0, v85
    v_add_f32 v86, 1.0, v86
    v_add_f32 v87, 1.0, v87
    v_add_f32 v88, 1.0, v88
    v_add_f32 v89, 1.0, v89
    v_add_f32 v90, 1.0, v90
    v_add_f32 v91, 1.0, v91
    v_add_f32 v92, 1.0, v92
    v_add_f32 v93, 1.0, v93
    v_add_f32 v94, 1.0, v94
    v_add_f32 v95, 1.0, v95
    s_setprio 2
    v_mfma_f32_32x32x16_bf16 v[64:79], v[204:207], v[152:155], 0
    v_rcp_f32 v80, v80
    v_rcp_f32 v81, v81
    v_rcp_f32 v82, v82
    s_waitcnt lgkmcnt(11)
    v_mfma_f32_32x32x16_bf16 v[64:79], v[180:183], v[144:147], v[64:79]
    v_rcp_f32 v83, v83
    v_rcp_f32 v84, v84
    v_rcp_f32 v85, v85
    s_waitcnt lgkmcnt(10)
    v_mfma_f32_32x32x16_bf16 v[64:79], v[184:187], v[148:151], v[64:79]
    v_rcp_f32 v86, v86
    v_rcp_f32 v87, v87
    v_rcp_f32 v88, v88
    v_rcp_f32 v89, v89
    s_waitcnt lgkmcnt(6)
    v_smfmac_f32_32x32x32_bf16 v[64:79], v[250:253], v[164:171], v254
    v_rcp_f32 v90, v90
    v_rcp_f32 v91, v91
    v_rcp_f32 v92, v92
    v_rcp_f32 v93, v93
    v_rcp_f32 v94, v94
    v_rcp_f32 v95, v95
    s_setprio 0
    ds_read_b64_tr_b16 v[188:189], v9 offset:0
    ds_read_b64_tr_b16 v[190:191], v10 offset:512
    ds_read_b64_tr_b16 v[192:193], v9 offset:1024
    s_add_u32 m0, s64, 67584
    ds_read_b64_tr_b16 v[194:195], v10 offset:1536
    buffer_load_dwordx4 v[26:27], s[44:47], 0 idxen offen lds
    ds_read_u16 v26, v4 offset:9824
    s_add_u32 m0, s64, 68608
    ds_write_b16 v15, v14
    buffer_load_dwordx4 v[28:29], s[44:47], 0 idxen offen lds
    ds_read_u16 v28, v4 offset:9840
    buffer_load_dwordx4 v[244:247], v[20:21], s[48:51], 0 idxen offen
    ds_read_b32 v20, v5 offset:1152
    ds_read_u16 v16, v6 offset:14272
    v_mul_f32 v112, v80, v112
    v_mul_f32 v113, v81, v113
    v_mul_f32 v114, v82, v114
    v_mul_f32 v115, v83, v115
    v_mul_f32 v116, v84, v116
    v_mul_f32 v117, v85, v117
    v_mul_f32 v118, v86, v118
    v_mul_f32 v119, v87, v119
    v_mul_f32 v120, v88, v120
    v_mul_f32 v121, v89, v121
    v_mul_f32 v122, v90, v122
    v_mul_f32 v123, v91, v123
    v_mul_f32 v124, v92, v124
    v_mul_f32 v125, v93, v125
    v_mul_f32 v126, v94, v126
    v_mul_f32 v127, v95, v127
    s_setprio 2
    v_cvt_pk_bf16_f32 v128, v80, v81
    v_cvt_pk_bf16_f32 v136, v112, v113
    v_cvt_pk_bf16_f32 v129, v82, v83
    v_cvt_pk_bf16_f32 v137, v114, v115
    s_waitcnt lgkmcnt(13)
    v_mfma_f32_32x32x16_bf16 v[96:111], v[156:159], v[172:175], 0
    v_cvt_pk_bf16_f32 v130, v84, v85
    v_cvt_pk_bf16_f32 v138, v116, v117
    v_cvt_pk_bf16_f32 v131, v86, v87
    v_cvt_pk_bf16_f32 v139, v118, v119
    v_cvt_pk_bf16_f32 v132, v88, v89
    v_cvt_pk_bf16_f32 v140, v120, v121
    v_cvt_pk_bf16_f32 v133, v90, v91
    v_cvt_pk_bf16_f32 v141, v122, v123
    s_waitcnt lgkmcnt(10)
    v_mfma_f32_32x32x16_bf16 v[96:111], v[160:163], v[176:179], v[96:111]
    v_cvt_pk_bf16_f32 v134, v92, v93
    v_cvt_pk_bf16_f32 v142, v124, v125
    v_cvt_pk_bf16_f32 v135, v94, v95
    v_cvt_pk_bf16_f32 v143, v126, v127
    s_sub_u32 s67, s67, 1
    s_cmp_eq_u32 s67, 0
    s_cbranch_scc1 L_exit1
    s_waitcnt lgkmcnt(0)
    s_waitcnt vmcnt(5)
    v_bitop3_b32 v16, v16, v240, 62 bitop3:0x28
    v_add_u32 v16, v241, v16
    s_setprio 2
    v_mfma_f32_32x32x16_bf16 v[32:47], v[128:131], v[196:199], v[32:47]
    v_exp_f32 v64, v64
    v_exp_f32 v65, v65
    v_exp_f32 v66, v66
    v_exp_f32 v67, v67
    v_mfma_f32_32x32x16_bf16 v[48:63], v[136:139], v[196:199], v[48:63]
    v_exp_f32 v68, v68
    v_exp_f32 v69, v69
    v_exp_f32 v70, v70
    v_exp_f32 v71, v71
    v_mfma_f32_32x32x16_bf16 v[32:47], v[132:135], v[200:203], v[32:47]
    v_exp_f32 v72, v72
    v_exp_f32 v73, v73
    v_exp_f32 v74, v74
    v_exp_f32 v75, v75
    v_mfma_f32_32x32x16_bf16 v[48:63], v[140:143], v[200:203], v[48:63]
    v_exp_f32 v76, v76
    v_exp_f32 v77, v77
    v_exp_f32 v78, v78
    v_exp_f32 v79, v79
    s_setprio 0
    ds_write_b16 v16, v13
    ds_read_b128 v[180:183], v7
    ds_read_b128 v[184:187], v8
    ds_read_b64_tr_b16 v[164:165], v11 offset:32768
    ds_read_b64_tr_b16 v[166:167], v11 offset:33792
    ds_read_b64_tr_b16 v[168:169], v11 offset:34816
    ds_read_b64_tr_b16 v[170:171], v11 offset:35840
    ds_read_b64_tr_b16 v[172:173], v12 offset:32768
    ds_read_b64_tr_b16 v[174:175], v12 offset:33792
    s_add_u32 m0, s64, 0
    ds_read_b64_tr_b16 v[176:177], v12 offset:34816
    buffer_load_dwordx4 v[22:23], s[44:47], 0 idxen offen lds
    ds_read_u16 v22, v4 offset:9856
    s_add_u32 m0, s64, 1024
    ds_read_b64_tr_b16 v[178:179], v12 offset:35840
    buffer_load_dwordx4 v[24:25], s[44:47], 0 idxen offen lds
    ds_read_u16 v24, v4 offset:9872
    v_add_f32 v64, 1.0, v64
    v_add_f32 v65, 1.0, v65
    v_add_f32 v66, 1.0, v66
    v_add_f32 v67, 1.0, v67
    v_add_f32 v68, 1.0, v68
    v_add_f32 v69, 1.0, v69
    v_add_f32 v70, 1.0, v70
    v_add_f32 v71, 1.0, v71
    v_add_f32 v72, 1.0, v72
    v_add_f32 v73, 1.0, v73
    v_add_f32 v74, 1.0, v74
    v_add_f32 v75, 1.0, v75
    v_add_f32 v76, 1.0, v76
    v_add_f32 v77, 1.0, v77
    v_add_f32 v78, 1.0, v78
    v_add_f32 v79, 1.0, v79
    s_setprio 2
    v_mfma_f32_32x32x16_bf16 v[80:95], v[208:211], v[152:155], 0
    v_rcp_f32 v64, v64
    v_rcp_f32 v65, v65
    v_rcp_f32 v66, v66
    s_waitcnt lgkmcnt(11)
    v_mfma_f32_32x32x16_bf16 v[80:95], v[180:183], v[144:147], v[80:95]
    v_rcp_f32 v67, v67
    v_rcp_f32 v68, v68
    v_rcp_f32 v69, v69
    s_waitcnt lgkmcnt(10)
    v_mfma_f32_32x32x16_bf16 v[80:95], v[184:187], v[148:151], v[80:95]
    v_rcp_f32 v70, v70
    v_rcp_f32 v71, v71
    v_rcp_f32 v72, v72
    v_rcp_f32 v73, v73
    s_waitcnt lgkmcnt(6)
    v_smfmac_f32_32x32x32_bf16 v[80:95], v[250:253], v[164:171], v254
    v_rcp_f32 v74, v74
    v_rcp_f32 v75, v75
    v_rcp_f32 v76, v76
    v_rcp_f32 v77, v77
    v_rcp_f32 v78, v78
    v_rcp_f32 v79, v79
    s_setprio 0
    ds_read_b64_tr_b16 v[196:197], v9 offset:0
    ds_read_b64_tr_b16 v[198:199], v10 offset:512
    ds_read_b64_tr_b16 v[200:201], v9 offset:1024
    s_add_u32 m0, s64, 2048
    ds_read_b64_tr_b16 v[202:203], v10 offset:1536
    buffer_load_dwordx4 v[26:27], s[44:47], 0 idxen offen lds
    ds_read_u16 v26, v4 offset:9888
    s_add_u32 m0, s64, 3072
    ds_write_b16 v16, v14
    buffer_load_dwordx4 v[28:29], s[44:47], 0 idxen offen lds
    ds_read_u16 v28, v4 offset:9904
    buffer_load_dwordx4 v[204:207], v[20:21], s[48:51], 0 idxen offen
    ds_read_b32 v20, v5 offset:1280
    ds_read_u16 v15, v6 offset:14336
    v_mul_f32 v96, v64, v96
    v_mul_f32 v97, v65, v97
    v_mul_f32 v98, v66, v98
    v_mul_f32 v99, v67, v99
    v_mul_f32 v100, v68, v100
    v_mul_f32 v101, v69, v101
    v_mul_f32 v102, v70, v102
    v_mul_f32 v103, v71, v103
    v_mul_f32 v104, v72, v104
    v_mul_f32 v105, v73, v105
    v_mul_f32 v106, v74, v106
    v_mul_f32 v107, v75, v107
    v_mul_f32 v108, v76, v108
    v_mul_f32 v109, v77, v109
    v_mul_f32 v110, v78, v110
    v_mul_f32 v111, v79, v111
    s_setprio 2
    v_cvt_pk_bf16_f32 v128, v64, v65
    v_cvt_pk_bf16_f32 v136, v96, v97
    v_cvt_pk_bf16_f32 v129, v66, v67
    v_cvt_pk_bf16_f32 v137, v98, v99
    s_waitcnt lgkmcnt(13)
    v_mfma_f32_32x32x16_bf16 v[112:127], v[156:159], v[172:175], 0
    v_cvt_pk_bf16_f32 v130, v68, v69
    v_cvt_pk_bf16_f32 v138, v100, v101
    v_cvt_pk_bf16_f32 v131, v70, v71
    v_cvt_pk_bf16_f32 v139, v102, v103
    v_cvt_pk_bf16_f32 v132, v72, v73
    v_cvt_pk_bf16_f32 v140, v104, v105
    v_cvt_pk_bf16_f32 v133, v74, v75
    v_cvt_pk_bf16_f32 v141, v106, v107
    s_waitcnt lgkmcnt(10)
    v_mfma_f32_32x32x16_bf16 v[112:127], v[160:163], v[176:179], v[112:127]
    v_cvt_pk_bf16_f32 v134, v76, v77
    v_cvt_pk_bf16_f32 v142, v108, v109
    v_cvt_pk_bf16_f32 v135, v78, v79
    v_cvt_pk_bf16_f32 v143, v110, v111
    v_add_u32 v4, 384, v4
    v_add_u32 v5, 768, v5
    v_add_u32 v6, 384, v6
    s_sub_u32 s67, s67, 1
    s_cmp_lg_u32 s67, 0
    s_cbranch_scc1 L_loop
    s_branch L_exit0
L_follower:
    s_mov_b32 s80, 16
    s_waitcnt lgkmcnt(0)
    s_waitcnt vmcnt(0)
    v_bitop3_b32 v16, v16, v240, 62 bitop3:0x28
    v_add_u32 v16, v241, v16
    ds_write_b16 v16, v13
    ds_read_b128 v[180:183], v7
    ds_read_b128 v[184:187], v8
    ds_read_b64_tr_b16 v[164:165], v11 offset:32768
    ds_read_b64_tr_b16 v[166:167], v11 offset:33792
    ds_read_b64_tr_b16 v[168:169], v11 offset:34816
    ds_read_b64_tr_b16 v[170:171], v11 offset:35840
    ds_read_b64_tr_b16 v[172:173], v12 offset:32768
    ds_read_b64_tr_b16 v[174:175], v12 offset:33792
    ds_read_b64_tr_b16 v[176:177], v12 offset:34816
    ds_read_b64_tr_b16 v[178:179], v12 offset:35840
    s_add_u32 m0, s64, 65536
    s_nop 0
    buffer_load_dwordx4 v[22:23], s[44:47], 0 idxen offen lds
    ds_read_u16 v22, v4 offset:9408
    s_add_u32 m0, s64, 66560
    s_nop 0
    buffer_load_dwordx4 v[24:25], s[44:47], 0 idxen offen lds
    ds_read_u16 v24, v4 offset:9424
    s_add_u32 m0, s64, 67584
    s_nop 0
    buffer_load_dwordx4 v[26:27], s[44:47], 0 idxen offen lds
    ds_read_u16 v26, v4 offset:9440
    s_add_u32 m0, s64, 68608
    s_nop 0
    buffer_load_dwordx4 v[28:29], s[44:47], 0 idxen offen lds
    ds_read_u16 v28, v4 offset:9456
    buffer_load_dwordx4 v[244:247], v[20:21], s[48:51], 0 idxen offen
    ds_read_b32 v20, v5 offset:384
    s_setprio 1
    v_mfma_f32_32x32x16_bf16 v[32:47], v[128:131], v[196:199], v[32:47]
    v_exp_f32 v64, v64
    v_exp_f32 v65, v65
    v_exp_f32 v66, v66
    v_exp_f32 v67, v67
    v_mfma_f32_32x32x16_bf16 v[48:63], v[136:139], v[196:199], v[48:63]
    v_exp_f32 v68, v68
    v_exp_f32 v69, v69
    v_exp_f32 v70, v70
    v_exp_f32 v71, v71
    v_mfma_f32_32x32x16_bf16 v[32:47], v[132:135], v[200:203], v[32:47]
    v_exp_f32 v72, v72
    v_exp_f32 v73, v73
    v_exp_f32 v74, v74
    v_exp_f32 v75, v75
    v_mfma_f32_32x32x16_bf16 v[48:63], v[140:143], v[200:203], v[48:63]
    v_exp_f32 v76, v76
    v_exp_f32 v77, v77
    v_exp_f32 v78, v78
    v_exp_f32 v79, v79
    s_setprio 0
    v_add_f32 v64, 1.0, v64
    v_add_f32 v65, 1.0, v65
    v_add_f32 v66, 1.0, v66
    v_add_f32 v67, 1.0, v67
    v_add_f32 v68, 1.0, v68
    v_add_f32 v69, 1.0, v69
    v_add_f32 v70, 1.0, v70
    v_add_f32 v71, 1.0, v71
    v_add_f32 v72, 1.0, v72
    v_add_f32 v73, 1.0, v73
    v_add_f32 v74, 1.0, v74
    v_add_f32 v75, 1.0, v75
    v_add_f32 v76, 1.0, v76
    v_add_f32 v77, 1.0, v77
    v_add_f32 v78, 1.0, v78
    v_add_f32 v79, 1.0, v79
    ds_read_b64_tr_b16 v[196:197], v9 offset:0
    ds_read_b64_tr_b16 v[198:199], v10 offset:512
    ds_read_b64_tr_b16 v[200:201], v9 offset:1024
    ds_read_b64_tr_b16 v[202:203], v10 offset:1536
    ds_write_b16 v16, v14
    s_waitcnt lgkmcnt(9)
    s_add_u32 m0, s64, 0
    s_nop 0
    buffer_load_dwordx4 v[22:23], s[44:47], 0 idxen offen lds
    ds_read_u16 v22, v4 offset:9472
    s_waitcnt lgkmcnt(9)
    s_add_u32 m0, s64, 1024
    s_nop 0
    buffer_load_dwordx4 v[24:25], s[44:47], 0 idxen offen lds
    ds_read_u16 v24, v4 offset:9488
    s_waitcnt lgkmcnt(9)
    s_add_u32 m0, s64, 2048
    s_nop 0
    buffer_load_dwordx4 v[26:27], s[44:47], 0 idxen offen lds
    ds_read_u16 v26, v4 offset:9504
    s_waitcnt lgkmcnt(9)
    s_add_u32 m0, s64, 3072
    s_nop 0
    buffer_load_dwordx4 v[28:29], s[44:47], 0 idxen offen lds
    ds_read_u16 v28, v4 offset:9520
    s_waitcnt lgkmcnt(9)
    buffer_load_dwordx4 v[204:207], v[20:21], s[48:51], 0 idxen offen
    ds_read_b32 v20, v5 offset:512
    ds_read_u16 v15, v6 offset:13952
    s_setprio 1
    v_mfma_f32_32x32x16_bf16 v[80:95], v[208:211], v[152:155], 0
    v_rcp_f32 v64, v64
    v_rcp_f32 v65, v65
    v_rcp_f32 v66, v66
    s_waitcnt lgkmcnt(15)
    v_mfma_f32_32x32x16_bf16 v[80:95], v[180:183], v[144:147], v[80:95]
    v_rcp_f32 v67, v67
    v_rcp_f32 v68, v68
    v_rcp_f32 v69, v69
    s_waitcnt lgkmcnt(15)
    v_mfma_f32_32x32x16_bf16 v[80:95], v[184:187], v[148:151], v[80:95]
    v_rcp_f32 v70, v70
    v_rcp_f32 v71, v71
    v_rcp_f32 v72, v72
    v_rcp_f32 v73, v73
    s_waitcnt lgkmcnt(15)
    v_smfmac_f32_32x32x32_bf16 v[80:95], v[250:253], v[164:171], v254
    v_rcp_f32 v74, v74
    v_rcp_f32 v75, v75
    v_rcp_f32 v76, v76
    v_rcp_f32 v77, v77
    v_rcp_f32 v78, v78
    v_rcp_f32 v79, v79
    s_setprio 0
    v_mul_f32 v96, v64, v96
    v_mul_f32 v97, v65, v97
    v_mul_f32 v98, v66, v98
    v_mul_f32 v99, v67, v99
    v_mul_f32 v100, v68, v100
    v_mul_f32 v101, v69, v101
    v_mul_f32 v102, v70, v102
    v_mul_f32 v103, v71, v103
    v_mul_f32 v104, v72, v104
    v_mul_f32 v105, v73, v105
    v_mul_f32 v106, v74, v106
    v_mul_f32 v107, v75, v107
    v_mul_f32 v108, v76, v108
    v_mul_f32 v109, v77, v109
    v_mul_f32 v110, v78, v110
    v_mul_f32 v111, v79, v111
    s_setprio 3
    v_cvt_pk_bf16_f32 v128, v64, v65
    v_cvt_pk_bf16_f32 v136, v96, v97
    v_cvt_pk_bf16_f32 v129, v66, v67
    v_cvt_pk_bf16_f32 v137, v98, v99
    s_waitcnt lgkmcnt(15)
    v_mfma_f32_32x32x16_bf16 v[112:127], v[156:159], v[172:175], 0
    v_cvt_pk_bf16_f32 v130, v68, v69
    v_cvt_pk_bf16_f32 v138, v100, v101
    v_cvt_pk_bf16_f32 v131, v70, v71
    v_cvt_pk_bf16_f32 v139, v102, v103
    v_cvt_pk_bf16_f32 v132, v72, v73
    v_cvt_pk_bf16_f32 v140, v104, v105
    v_cvt_pk_bf16_f32 v133, v74, v75
    v_cvt_pk_bf16_f32 v141, v106, v107
    s_waitcnt lgkmcnt(15)
    v_mfma_f32_32x32x16_bf16 v[112:127], v[160:163], v[176:179], v[112:127]
    v_cvt_pk_bf16_f32 v134, v76, v77
    v_cvt_pk_bf16_f32 v142, v108, v109
    v_cvt_pk_bf16_f32 v135, v78, v79
    v_cvt_pk_bf16_f32 v143, v110, v111
    s_sub_u32 s67, s67, 1
    s_cmp_eq_u32 s67, 0
    s_cbranch_scc1 L_exit0
L_loopF:
    s_waitcnt lgkmcnt(0)
    s_waitcnt vmcnt(5)
    v_bitop3_b32 v15, v15, v240, 62 bitop3:0x28
    v_add_u32 v15, v241, v15
    ds_write_b16 v15, v13
    ds_read_b128 v[180:183], v7
    ds_read_b128 v[184:187], v8
    ds_read_b64_tr_b16 v[164:165], v248 offset:0
    ds_read_b64_tr_b16 v[166:167], v248 offset:1024
    ds_read_b64_tr_b16 v[168:169], v248 offset:2048
    ds_read_b64_tr_b16 v[170:171], v248 offset:3072
    ds_read_b64_tr_b16 v[172:173], v249 offset:0
    ds_read_b64_tr_b16 v[174:175], v249 offset:1024
    s_add_u32 m0, s64, 32768
    ds_read_b64_tr_b16 v[176:177], v249 offset:2048
    buffer_load_dwordx4 v[22:23], s[44:47], 0 idxen offen lds
    ds_read_u16 v22, v4 offset:9536
    s_add_u32 m0, s64, 33792
    ds_read_b64_tr_b16 v[178:179], v249 offset:3072
    buffer_load_dwordx4 v[24:25], s[44:47], 0 idxen offen lds
    ds_read_u16 v24, v4 offset:9552
    s_setprio 1
    v_mfma_f32_32x32x16_bf16 v[32:47], v[128:131], v[188:191], v[32:47]
    v_exp_f32 v80, v80
    v_exp_f32 v81, v81
    v_exp_f32 v82, v82
    v_exp_f32 v83, v83
    v_mfma_f32_32x32x16_bf16 v[48:63], v[136:139], v[188:191], v[48:63]
    v_exp_f32 v84, v84
    v_exp_f32 v85, v85
    v_exp_f32 v86, v86
    v_exp_f32 v87, v87
    v_mfma_f32_32x32x16_bf16 v[32:47], v[132:135], v[192:195], v[32:47]
    v_exp_f32 v88, v88
    v_exp_f32 v89, v89
    v_exp_f32 v90, v90
    v_exp_f32 v91, v91
    v_mfma_f32_32x32x16_bf16 v[48:63], v[140:143], v[192:195], v[48:63]
    v_exp_f32 v92, v92
    v_exp_f32 v93, v93
    v_exp_f32 v94, v94
    v_exp_f32 v95, v95
    s_setprio 0
    v_add_f32 v80, 1.0, v80
    v_add_f32 v81, 1.0, v81
    v_add_f32 v82, 1.0, v82
    v_add_f32 v83, 1.0, v83
    v_add_f32 v84, 1.0, v84
    v_add_f32 v85, 1.0, v85
    v_add_f32 v86, 1.0, v86
    v_add_f32 v87, 1.0, v87
    v_add_f32 v88, 1.0, v88
    v_add_f32 v89, 1.0, v89
    v_add_f32 v90, 1.0, v90
    v_add_f32 v91, 1.0, v91
    v_add_f32 v92, 1.0, v92
    v_add_f32 v93, 1.0, v93
    v_add_f32 v94, 1.0, v94
    v_add_f32 v95, 1.0, v95
    ds_read_b64_tr_b16 v[188:189], v9 offset:0
    ds_read_b64_tr_b16 v[190:191], v10 offset:512
    ds_read_b64_tr_b16 v[192:193], v9 offset:1024
    s_add_u32 m0, s64, 34816
    ds_read_b64_tr_b16 v[194:195], v10 offset:1536
    buffer_load_dwordx4 v[26:27], s[44:47], 0 idxen offen lds
    ds_read_u16 v26, v4 offset:9568
    s_add_u32 m0, s64, 35840
    ds_write_b16 v15, v14
    buffer_load_dwordx4 v[28:29], s[44:47], 0 idxen offen lds
    ds_read_u16 v28, v4 offset:9584
    buffer_load_dwordx4 v[208:211], v[20:21], s[48:51], 0 idxen offen
    ds_read_b32 v20, v5 offset:640
    ds_read_u16 v16, v6 offset:14016
    s_setprio 1
    v_mfma_f32_32x32x16_bf16 v[64:79], v[244:247], v[152:155], 0
    v_rcp_f32 v80, v80
    v_rcp_f32 v81, v81
    v_rcp_f32 v82, v82
    s_waitcnt lgkmcnt(15)
    v_mfma_f32_32x32x16_bf16 v[64:79], v[180:183], v[144:147], v[64:79]
    v_rcp_f32 v83, v83
    v_rcp_f32 v84, v84
    v_rcp_f32 v85, v85
    s_waitcnt lgkmcnt(15)
    v_mfma_f32_32x32x16_bf16 v[64:79], v[184:187], v[148:151], v[64:79]
    v_rcp_f32 v86, v86
    v_rcp_f32 v87, v87
    v_rcp_f32 v88, v88
    v_rcp_f32 v89, v89
    s_waitcnt lgkmcnt(15)
    v_smfmac_f32_32x32x32_bf16 v[64:79], v[250:253], v[164:171], v254
    v_rcp_f32 v90, v90
    v_rcp_f32 v91, v91
    v_rcp_f32 v92, v92
    v_rcp_f32 v93, v93
    v_rcp_f32 v94, v94
    v_rcp_f32 v95, v95
    s_setprio 0
    v_mul_f32 v112, v80, v112
    v_mul_f32 v113, v81, v113
    v_mul_f32 v114, v82, v114
    v_mul_f32 v115, v83, v115
    v_mul_f32 v116, v84, v116
    v_mul_f32 v117, v85, v117
    v_mul_f32 v118, v86, v118
    v_mul_f32 v119, v87, v119
    v_mul_f32 v120, v88, v120
    v_mul_f32 v121, v89, v121
    v_mul_f32 v122, v90, v122
    v_mul_f32 v123, v91, v123
    v_mul_f32 v124, v92, v124
    v_mul_f32 v125, v93, v125
    v_mul_f32 v126, v94, v126
    v_mul_f32 v127, v95, v127
    s_setprio 3
    v_cvt_pk_bf16_f32 v128, v80, v81
    v_cvt_pk_bf16_f32 v136, v112, v113
    v_cvt_pk_bf16_f32 v129, v82, v83
    v_cvt_pk_bf16_f32 v137, v114, v115
    s_waitcnt lgkmcnt(13)
    v_mfma_f32_32x32x16_bf16 v[96:111], v[156:159], v[172:175], 0
    v_cvt_pk_bf16_f32 v130, v84, v85
    v_cvt_pk_bf16_f32 v138, v116, v117
    v_cvt_pk_bf16_f32 v131, v86, v87
    v_cvt_pk_bf16_f32 v139, v118, v119
    v_cvt_pk_bf16_f32 v132, v88, v89
    v_cvt_pk_bf16_f32 v140, v120, v121
    v_cvt_pk_bf16_f32 v133, v90, v91
    v_cvt_pk_bf16_f32 v141, v122, v123
    s_waitcnt lgkmcnt(10)
    v_mfma_f32_32x32x16_bf16 v[96:111], v[160:163], v[176:179], v[96:111]
    v_cvt_pk_bf16_f32 v134, v92, v93
    v_cvt_pk_bf16_f32 v142, v124, v125
    v_cvt_pk_bf16_f32 v135, v94, v95
    v_cvt_pk_bf16_f32 v143, v126, v127
    s_sub_u32 s67, s67, 1
    s_cmp_eq_u32 s67, 0
    s_cbranch_scc1 L_exit1
    s_waitcnt lgkmcnt(0)
    s_waitcnt vmcnt(5)
    v_bitop3_b32 v16, v16, v240, 62 bitop3:0x28
    v_add_u32 v16, v241, v16
    ds_write_b16 v16, v13
    ds_read_b128 v[180:183], v7
    ds_read_b128 v[184:187], v8
    ds_read_b64_tr_b16 v[164:165], v11 offset:0
    ds_read_b64_tr_b16 v[166:167], v11 offset:1024
    ds_read_b64_tr_b16 v[168:169], v11 offset:2048
    ds_read_b64_tr_b16 v[170:171], v11 offset:3072
    ds_read_b64_tr_b16 v[172:173], v12 offset:0
    ds_read_b64_tr_b16 v[174:175], v12 offset:1024
    s_add_u32 m0, s64, 65536
    ds_read_b64_tr_b16 v[176:177], v12 offset:2048
    buffer_load_dwordx4 v[22:23], s[44:47], 0 idxen offen lds
    ds_read_u16 v22, v4 offset:9600
    s_add_u32 m0, s64, 66560
    ds_read_b64_tr_b16 v[178:179], v12 offset:3072
    buffer_load_dwordx4 v[24:25], s[44:47], 0 idxen offen lds
    ds_read_u16 v24, v4 offset:9616
    s_setprio 1
    v_mfma_f32_32x32x16_bf16 v[32:47], v[128:131], v[196:199], v[32:47]
    v_exp_f32 v64, v64
    v_exp_f32 v65, v65
    v_exp_f32 v66, v66
    v_exp_f32 v67, v67
    v_mfma_f32_32x32x16_bf16 v[48:63], v[136:139], v[196:199], v[48:63]
    v_exp_f32 v68, v68
    v_exp_f32 v69, v69
    v_exp_f32 v70, v70
    v_exp_f32 v71, v71
    v_mfma_f32_32x32x16_bf16 v[32:47], v[132:135], v[200:203], v[32:47]
    v_exp_f32 v72, v72
    v_exp_f32 v73, v73
    v_exp_f32 v74, v74
    v_exp_f32 v75, v75
    v_mfma_f32_32x32x16_bf16 v[48:63], v[140:143], v[200:203], v[48:63]
    v_exp_f32 v76, v76
    v_exp_f32 v77, v77
    v_exp_f32 v78, v78
    v_exp_f32 v79, v79
    s_setprio 0
    v_add_f32 v64, 1.0, v64
    v_add_f32 v65, 1.0, v65
    v_add_f32 v66, 1.0, v66
    v_add_f32 v67, 1.0, v67
    v_add_f32 v68, 1.0, v68
    v_add_f32 v69, 1.0, v69
    v_add_f32 v70, 1.0, v70
    v_add_f32 v71, 1.0, v71
    v_add_f32 v72, 1.0, v72
    v_add_f32 v73, 1.0, v73
    v_add_f32 v74, 1.0, v74
    v_add_f32 v75, 1.0, v75
    v_add_f32 v76, 1.0, v76
    v_add_f32 v77, 1.0, v77
    v_add_f32 v78, 1.0, v78
    v_add_f32 v79, 1.0, v79
    ds_read_b64_tr_b16 v[196:197], v9 offset:0
    ds_read_b64_tr_b16 v[198:199], v10 offset:512
    ds_read_b64_tr_b16 v[200:201], v9 offset:1024
    s_add_u32 m0, s64, 67584
    ds_read_b64_tr_b16 v[202:203], v10 offset:1536
    buffer_load_dwordx4 v[26:27], s[44:47], 0 idxen offen lds
    ds_read_u16 v26, v4 offset:9632
    s_add_u32 m0, s64, 68608
    ds_write_b16 v16, v14
    buffer_load_dwordx4 v[28:29], s[44:47], 0 idxen offen lds
    ds_read_u16 v28, v4 offset:9648
    buffer_load_dwordx4 v[244:247], v[20:21], s[48:51], 0 idxen offen
    ds_read_b32 v20, v5 offset:768
    ds_read_u16 v15, v6 offset:14080
    s_setprio 1
    v_mfma_f32_32x32x16_bf16 v[80:95], v[204:207], v[152:155], 0
    v_rcp_f32 v64, v64
    v_rcp_f32 v65, v65
    v_rcp_f32 v66, v66
    s_waitcnt lgkmcnt(15)
    v_mfma_f32_32x32x16_bf16 v[80:95], v[180:183], v[144:147], v[80:95]
    v_rcp_f32 v67, v67
    v_rcp_f32 v68, v68
    v_rcp_f32 v69, v69
    s_waitcnt lgkmcnt(15)
    v_mfma_f32_32x32x16_bf16 v[80:95], v[184:187], v[148:151], v[80:95]
    v_rcp_f32 v70, v70
    v_rcp_f32 v71, v71
    v_rcp_f32 v72, v72
    v_rcp_f32 v73, v73
    s_waitcnt lgkmcnt(15)
    v_smfmac_f32_32x32x32_bf16 v[80:95], v[250:253], v[164:171], v254
    v_rcp_f32 v74, v74
    v_rcp_f32 v75, v75
    v_rcp_f32 v76, v76
    v_rcp_f32 v77, v77
    v_rcp_f32 v78, v78
    v_rcp_f32 v79, v79
    s_setprio 0
    v_mul_f32 v96, v64, v96
    v_mul_f32 v97, v65, v97
    v_mul_f32 v98, v66, v98
    v_mul_f32 v99, v67, v99
    v_mul_f32 v100, v68, v100
    v_mul_f32 v101, v69, v101
    v_mul_f32 v102, v70, v102
    v_mul_f32 v103, v71, v103
    v_mul_f32 v104, v72, v104
    v_mul_f32 v105, v73, v105
    v_mul_f32 v106, v74, v106
    v_mul_f32 v107, v75, v107
    v_mul_f32 v108, v76, v108
    v_mul_f32 v109, v77, v109
    v_mul_f32 v110, v78, v110
    v_mul_f32 v111, v79, v111
    s_setprio 3
    v_cvt_pk_bf16_f32 v128, v64, v65
    v_cvt_pk_bf16_f32 v136, v96, v97
    v_cvt_pk_bf16_f32 v129, v66, v67
    v_cvt_pk_bf16_f32 v137, v98, v99
    s_waitcnt lgkmcnt(13)
    v_mfma_f32_32x32x16_bf16 v[112:127], v[156:159], v[172:175], 0
    v_cvt_pk_bf16_f32 v130, v68, v69
    v_cvt_pk_bf16_f32 v138, v100, v101
    v_cvt_pk_bf16_f32 v131, v70, v71
    v_cvt_pk_bf16_f32 v139, v102, v103
    v_cvt_pk_bf16_f32 v132, v72, v73
    v_cvt_pk_bf16_f32 v140, v104, v105
    v_cvt_pk_bf16_f32 v133, v74, v75
    v_cvt_pk_bf16_f32 v141, v106, v107
    s_waitcnt lgkmcnt(10)
    v_mfma_f32_32x32x16_bf16 v[112:127], v[160:163], v[176:179], v[112:127]
    v_cvt_pk_bf16_f32 v134, v76, v77
    v_cvt_pk_bf16_f32 v142, v108, v109
    v_cvt_pk_bf16_f32 v135, v78, v79
    v_cvt_pk_bf16_f32 v143, v110, v111
    s_sub_u32 s67, s67, 1
    s_cmp_eq_u32 s67, 0
    s_cbranch_scc1 L_exit0
    s_waitcnt lgkmcnt(0)
    s_waitcnt vmcnt(5)
    v_bitop3_b32 v15, v15, v240, 62 bitop3:0x28
    v_add_u32 v15, v241, v15
    ds_write_b16 v15, v13
    ds_read_b128 v[180:183], v7
    ds_read_b128 v[184:187], v8
    ds_read_b64_tr_b16 v[164:165], v11 offset:32768
    ds_read_b64_tr_b16 v[166:167], v11 offset:33792
    ds_read_b64_tr_b16 v[168:169], v11 offset:34816
    ds_read_b64_tr_b16 v[170:171], v11 offset:35840
    ds_read_b64_tr_b16 v[172:173], v12 offset:32768
    ds_read_b64_tr_b16 v[174:175], v12 offset:33792
    s_add_u32 m0, s64, 0
    ds_read_b64_tr_b16 v[176:177], v12 offset:34816
    buffer_load_dwordx4 v[22:23], s[44:47], 0 idxen offen lds
    ds_read_u16 v22, v4 offset:9664
    s_add_u32 m0, s64, 1024
    ds_read_b64_tr_b16 v[178:179], v12 offset:35840
    buffer_load_dwordx4 v[24:25], s[44:47], 0 idxen offen lds
    ds_read_u16 v24, v4 offset:9680
    s_setprio 1
    v_mfma_f32_32x32x16_bf16 v[32:47], v[128:131], v[188:191], v[32:47]
    v_exp_f32 v80, v80
    v_exp_f32 v81, v81
    v_exp_f32 v82, v82
    v_exp_f32 v83, v83
    v_mfma_f32_32x32x16_bf16 v[48:63], v[136:139], v[188:191], v[48:63]
    v_exp_f32 v84, v84
    v_exp_f32 v85, v85
    v_exp_f32 v86, v86
    v_exp_f32 v87, v87
    v_mfma_f32_32x32x16_bf16 v[32:47], v[132:135], v[192:195], v[32:47]
    v_exp_f32 v88, v88
    v_exp_f32 v89, v89
    v_exp_f32 v90, v90
    v_exp_f32 v91, v91
    v_mfma_f32_32x32x16_bf16 v[48:63], v[140:143], v[192:195], v[48:63]
    v_exp_f32 v92, v92
    v_exp_f32 v93, v93
    v_exp_f32 v94, v94
    v_exp_f32 v95, v95
    s_setprio 0
    v_add_f32 v80, 1.0, v80
    v_add_f32 v81, 1.0, v81
    v_add_f32 v82, 1.0, v82
    v_add_f32 v83, 1.0, v83
    v_add_f32 v84, 1.0, v84
    v_add_f32 v85, 1.0, v85
    v_add_f32 v86, 1.0, v86
    v_add_f32 v87, 1.0, v87
    v_add_f32 v88, 1.0, v88
    v_add_f32 v89, 1.0, v89
    v_add_f32 v90, 1.0, v90
    v_add_f32 v91, 1.0, v91
    v_add_f32 v92, 1.0, v92
    v_add_f32 v93, 1.0, v93
    v_add_f32 v94, 1.0, v94
    v_add_f32 v95, 1.0, v95
    ds_read_b64_tr_b16 v[188:189], v9 offset:0
    ds_read_b64_tr_b16 v[190:191], v10 offset:512
    ds_read_b64_tr_b16 v[192:193], v9 offset:1024
    s_add_u32 m0, s64, 2048
    ds_read_b64_tr_b16 v[194:195], v10 offset:1536
    buffer_load_dwordx4 v[26:27], s[44:47], 0 idxen offen lds
    ds_read_u16 v26, v4 offset:9696
    s_add_u32 m0, s64, 3072
    ds_write_b16 v15, v14
    buffer_load_dwordx4 v[28:29], s[44:47], 0 idxen offen lds
    ds_read_u16 v28, v4 offset:9712
    buffer_load_dwordx4 v[204:207], v[20:21], s[48:51], 0 idxen offen
    ds_read_b32 v20, v5 offset:896
    ds_read_u16 v16, v6 offset:14144
    s_setprio 1
    v_mfma_f32_32x32x16_bf16 v[64:79], v[208:211], v[152:155], 0
    v_rcp_f32 v80, v80
    v_rcp_f32 v81, v81
    v_rcp_f32 v82, v82
    s_waitcnt lgkmcnt(15)
    v_mfma_f32_32x32x16_bf16 v[64:79], v[180:183], v[144:147], v[64:79]
    v_rcp_f32 v83, v83
    v_rcp_f32 v84, v84
    v_rcp_f32 v85, v85
    s_waitcnt lgkmcnt(15)
    v_mfma_f32_32x32x16_bf16 v[64:79], v[184:187], v[148:151], v[64:79]
    v_rcp_f32 v86, v86
    v_rcp_f32 v87, v87
    v_rcp_f32 v88, v88
    v_rcp_f32 v89, v89
    s_waitcnt lgkmcnt(15)
    v_smfmac_f32_32x32x32_bf16 v[64:79], v[250:253], v[164:171], v254
    v_rcp_f32 v90, v90
    v_rcp_f32 v91, v91
    v_rcp_f32 v92, v92
    v_rcp_f32 v93, v93
    v_rcp_f32 v94, v94
    v_rcp_f32 v95, v95
    s_setprio 0
    v_mul_f32 v112, v80, v112
    v_mul_f32 v113, v81, v113
    v_mul_f32 v114, v82, v114
    v_mul_f32 v115, v83, v115
    v_mul_f32 v116, v84, v116
    v_mul_f32 v117, v85, v117
    v_mul_f32 v118, v86, v118
    v_mul_f32 v119, v87, v119
    v_mul_f32 v120, v88, v120
    v_mul_f32 v121, v89, v121
    v_mul_f32 v122, v90, v122
    v_mul_f32 v123, v91, v123
    v_mul_f32 v124, v92, v124
    v_mul_f32 v125, v93, v125
    v_mul_f32 v126, v94, v126
    v_mul_f32 v127, v95, v127
    s_setprio 3
    v_cvt_pk_bf16_f32 v128, v80, v81
    v_cvt_pk_bf16_f32 v136, v112, v113
    v_cvt_pk_bf16_f32 v129, v82, v83
    v_cvt_pk_bf16_f32 v137, v114, v115
    s_waitcnt lgkmcnt(13)
    v_mfma_f32_32x32x16_bf16 v[96:111], v[156:159], v[172:175], 0
    v_cvt_pk_bf16_f32 v130, v84, v85
    v_cvt_pk_bf16_f32 v138, v116, v117
    v_cvt_pk_bf16_f32 v131, v86, v87
    v_cvt_pk_bf16_f32 v139, v118, v119
    v_cvt_pk_bf16_f32 v132, v88, v89
    v_cvt_pk_bf16_f32 v140, v120, v121
    v_cvt_pk_bf16_f32 v133, v90, v91
    v_cvt_pk_bf16_f32 v141, v122, v123
    s_waitcnt lgkmcnt(10)
    v_mfma_f32_32x32x16_bf16 v[96:111], v[160:163], v[176:179], v[96:111]
    v_cvt_pk_bf16_f32 v134, v92, v93
    v_cvt_pk_bf16_f32 v142, v124, v125
    v_cvt_pk_bf16_f32 v135, v94, v95
    v_cvt_pk_bf16_f32 v143, v126, v127
    s_sub_u32 s67, s67, 1
    s_cmp_eq_u32 s67, 0
    s_cbranch_scc1 L_exit1
    s_waitcnt lgkmcnt(0)
    s_waitcnt vmcnt(5)
    v_bitop3_b32 v16, v16, v240, 62 bitop3:0x28
    v_add_u32 v16, v241, v16
    ds_write_b16 v16, v13
    ds_read_b128 v[180:183], v7
    ds_read_b128 v[184:187], v8
    ds_read_b64_tr_b16 v[164:165], v248 offset:0
    ds_read_b64_tr_b16 v[166:167], v248 offset:1024
    ds_read_b64_tr_b16 v[168:169], v248 offset:2048
    ds_read_b64_tr_b16 v[170:171], v248 offset:3072
    ds_read_b64_tr_b16 v[172:173], v249 offset:0
    ds_read_b64_tr_b16 v[174:175], v249 offset:1024
    s_add_u32 m0, s64, 32768
    ds_read_b64_tr_b16 v[176:177], v249 offset:2048
    buffer_load_dwordx4 v[22:23], s[44:47], 0 idxen offen lds
    ds_read_u16 v22, v4 offset:9728
    s_add_u32 m0, s64, 33792
    ds_read_b64_tr_b16 v[178:179], v249 offset:3072
    buffer_load_dwordx4 v[24:25], s[44:47], 0 idxen offen lds
    ds_read_u16 v24, v4 offset:9744
    s_setprio 1
    v_mfma_f32_32x32x16_bf16 v[32:47], v[128:131], v[196:199], v[32:47]
    v_exp_f32 v64, v64
    v_exp_f32 v65, v65
    v_exp_f32 v66, v66
    v_exp_f32 v67, v67
    v_mfma_f32_32x32x16_bf16 v[48:63], v[136:139], v[196:199], v[48:63]
    v_exp_f32 v68, v68
    v_exp_f32 v69, v69
    v_exp_f32 v70, v70
    v_exp_f32 v71, v71
    v_mfma_f32_32x32x16_bf16 v[32:47], v[132:135], v[200:203], v[32:47]
    v_exp_f32 v72, v72
    v_exp_f32 v73, v73
    v_exp_f32 v74, v74
    v_exp_f32 v75, v75
    v_mfma_f32_32x32x16_bf16 v[48:63], v[140:143], v[200:203], v[48:63]
    v_exp_f32 v76, v76
    v_exp_f32 v77, v77
    v_exp_f32 v78, v78
    v_exp_f32 v79, v79
    s_setprio 0
    v_add_f32 v64, 1.0, v64
    v_add_f32 v65, 1.0, v65
    v_add_f32 v66, 1.0, v66
    v_add_f32 v67, 1.0, v67
    v_add_f32 v68, 1.0, v68
    v_add_f32 v69, 1.0, v69
    v_add_f32 v70, 1.0, v70
    v_add_f32 v71, 1.0, v71
    v_add_f32 v72, 1.0, v72
    v_add_f32 v73, 1.0, v73
    v_add_f32 v74, 1.0, v74
    v_add_f32 v75, 1.0, v75
    v_add_f32 v76, 1.0, v76
    v_add_f32 v77, 1.0, v77
    v_add_f32 v78, 1.0, v78
    v_add_f32 v79, 1.0, v79
    ds_read_b64_tr_b16 v[196:197], v9 offset:0
    ds_read_b64_tr_b16 v[198:199], v10 offset:512
    ds_read_b64_tr_b16 v[200:201], v9 offset:1024
    s_add_u32 m0, s64, 34816
    ds_read_b64_tr_b16 v[202:203], v10 offset:1536
    buffer_load_dwordx4 v[26:27], s[44:47], 0 idxen offen lds
    ds_read_u16 v26, v4 offset:9760
    s_add_u32 m0, s64, 35840
    ds_write_b16 v16, v14
    buffer_load_dwordx4 v[28:29], s[44:47], 0 idxen offen lds
    ds_read_u16 v28, v4 offset:9776
    buffer_load_dwordx4 v[208:211], v[20:21], s[48:51], 0 idxen offen
    ds_read_b32 v20, v5 offset:1024
    ds_read_u16 v15, v6 offset:14208
    s_setprio 1
    v_mfma_f32_32x32x16_bf16 v[80:95], v[244:247], v[152:155], 0
    v_rcp_f32 v64, v64
    v_rcp_f32 v65, v65
    v_rcp_f32 v66, v66
    s_waitcnt lgkmcnt(15)
    v_mfma_f32_32x32x16_bf16 v[80:95], v[180:183], v[144:147], v[80:95]
    v_rcp_f32 v67, v67
    v_rcp_f32 v68, v68
    v_rcp_f32 v69, v69
    s_waitcnt lgkmcnt(15)
    v_mfma_f32_32x32x16_bf16 v[80:95], v[184:187], v[148:151], v[80:95]
    v_rcp_f32 v70, v70
    v_rcp_f32 v71, v71
    v_rcp_f32 v72, v72
    v_rcp_f32 v73, v73
    s_waitcnt lgkmcnt(15)
    v_smfmac_f32_32x32x32_bf16 v[80:95], v[250:253], v[164:171], v254
    v_rcp_f32 v74, v74
    v_rcp_f32 v75, v75
    v_rcp_f32 v76, v76
    v_rcp_f32 v77, v77
    v_rcp_f32 v78, v78
    v_rcp_f32 v79, v79
    s_setprio 0
    v_mul_f32 v96, v64, v96
    v_mul_f32 v97, v65, v97
    v_mul_f32 v98, v66, v98
    v_mul_f32 v99, v67, v99
    v_mul_f32 v100, v68, v100
    v_mul_f32 v101, v69, v101
    v_mul_f32 v102, v70, v102
    v_mul_f32 v103, v71, v103
    v_mul_f32 v104, v72, v104
    v_mul_f32 v105, v73, v105
    v_mul_f32 v106, v74, v106
    v_mul_f32 v107, v75, v107
    v_mul_f32 v108, v76, v108
    v_mul_f32 v109, v77, v109
    v_mul_f32 v110, v78, v110
    v_mul_f32 v111, v79, v111
    s_setprio 3
    v_cvt_pk_bf16_f32 v128, v64, v65
    v_cvt_pk_bf16_f32 v136, v96, v97
    v_cvt_pk_bf16_f32 v129, v66, v67
    v_cvt_pk_bf16_f32 v137, v98, v99
    s_waitcnt lgkmcnt(13)
    v_mfma_f32_32x32x16_bf16 v[112:127], v[156:159], v[172:175], 0
    v_cvt_pk_bf16_f32 v130, v68, v69
    v_cvt_pk_bf16_f32 v138, v100, v101
    v_cvt_pk_bf16_f32 v131, v70, v71
    v_cvt_pk_bf16_f32 v139, v102, v103
    v_cvt_pk_bf16_f32 v132, v72, v73
    v_cvt_pk_bf16_f32 v140, v104, v105
    v_cvt_pk_bf16_f32 v133, v74, v75
    v_cvt_pk_bf16_f32 v141, v106, v107
    s_waitcnt lgkmcnt(10)
    v_mfma_f32_32x32x16_bf16 v[112:127], v[160:163], v[176:179], v[112:127]
    v_cvt_pk_bf16_f32 v134, v76, v77
    v_cvt_pk_bf16_f32 v142, v108, v109
    v_cvt_pk_bf16_f32 v135, v78, v79
    v_cvt_pk_bf16_f32 v143, v110, v111
    s_sub_u32 s67, s67, 1
    s_cmp_eq_u32 s67, 0
    s_cbranch_scc1 L_exit0
    s_waitcnt lgkmcnt(0)
    s_waitcnt vmcnt(5)
    v_bitop3_b32 v15, v15, v240, 62 bitop3:0x28
    v_add_u32 v15, v241, v15
    ds_write_b16 v15, v13
    ds_read_b128 v[180:183], v7
    ds_read_b128 v[184:187], v8
    ds_read_b64_tr_b16 v[164:165], v11 offset:0
    ds_read_b64_tr_b16 v[166:167], v11 offset:1024
    ds_read_b64_tr_b16 v[168:169], v11 offset:2048
    ds_read_b64_tr_b16 v[170:171], v11 offset:3072
    ds_read_b64_tr_b16 v[172:173], v12 offset:0
    ds_read_b64_tr_b16 v[174:175], v12 offset:1024
    s_add_u32 m0, s64, 65536
    ds_read_b64_tr_b16 v[176:177], v12 offset:2048
    buffer_load_dwordx4 v[22:23], s[44:47], 0 idxen offen lds
    ds_read_u16 v22, v4 offset:9792
    s_add_u32 m0, s64, 66560
    ds_read_b64_tr_b16 v[178:179], v12 offset:3072
    buffer_load_dwordx4 v[24:25], s[44:47], 0 idxen offen lds
    ds_read_u16 v24, v4 offset:9808
    s_setprio 1
    v_mfma_f32_32x32x16_bf16 v[32:47], v[128:131], v[188:191], v[32:47]
    v_exp_f32 v80, v80
    v_exp_f32 v81, v81
    v_exp_f32 v82, v82
    v_exp_f32 v83, v83
    v_mfma_f32_32x32x16_bf16 v[48:63], v[136:139], v[188:191], v[48:63]
    v_exp_f32 v84, v84
    v_exp_f32 v85, v85
    v_exp_f32 v86, v86
    v_exp_f32 v87, v87
    v_mfma_f32_32x32x16_bf16 v[32:47], v[132:135], v[192:195], v[32:47]
    v_exp_f32 v88, v88
    v_exp_f32 v89, v89
    v_exp_f32 v90, v90
    v_exp_f32 v91, v91
    v_mfma_f32_32x32x16_bf16 v[48:63], v[140:143], v[192:195], v[48:63]
    v_exp_f32 v92, v92
    v_exp_f32 v93, v93
    v_exp_f32 v94, v94
    v_exp_f32 v95, v95
    s_setprio 0
    v_add_f32 v80, 1.0, v80
    v_add_f32 v81, 1.0, v81
    v_add_f32 v82, 1.0, v82
    v_add_f32 v83, 1.0, v83
    v_add_f32 v84, 1.0, v84
    v_add_f32 v85, 1.0, v85
    v_add_f32 v86, 1.0, v86
    v_add_f32 v87, 1.0, v87
    v_add_f32 v88, 1.0, v88
    v_add_f32 v89, 1.0, v89
    v_add_f32 v90, 1.0, v90
    v_add_f32 v91, 1.0, v91
    v_add_f32 v92, 1.0, v92
    v_add_f32 v93, 1.0, v93
    v_add_f32 v94, 1.0, v94
    v_add_f32 v95, 1.0, v95
    ds_read_b64_tr_b16 v[188:189], v9 offset:0
    ds_read_b64_tr_b16 v[190:191], v10 offset:512
    ds_read_b64_tr_b16 v[192:193], v9 offset:1024
    s_add_u32 m0, s64, 67584
    ds_read_b64_tr_b16 v[194:195], v10 offset:1536
    buffer_load_dwordx4 v[26:27], s[44:47], 0 idxen offen lds
    ds_read_u16 v26, v4 offset:9824
    s_add_u32 m0, s64, 68608
    ds_write_b16 v15, v14
    buffer_load_dwordx4 v[28:29], s[44:47], 0 idxen offen lds
    ds_read_u16 v28, v4 offset:9840
    buffer_load_dwordx4 v[244:247], v[20:21], s[48:51], 0 idxen offen
    ds_read_b32 v20, v5 offset:1152
    ds_read_u16 v16, v6 offset:14272
    s_setprio 1
    v_mfma_f32_32x32x16_bf16 v[64:79], v[204:207], v[152:155], 0
    v_rcp_f32 v80, v80
    v_rcp_f32 v81, v81
    v_rcp_f32 v82, v82
    s_waitcnt lgkmcnt(15)
    v_mfma_f32_32x32x16_bf16 v[64:79], v[180:183], v[144:147], v[64:79]
    v_rcp_f32 v83, v83
    v_rcp_f32 v84, v84
    v_rcp_f32 v85, v85
    s_waitcnt lgkmcnt(15)
    v_mfma_f32_32x32x16_bf16 v[64:79], v[184:187], v[148:151], v[64:79]
    v_rcp_f32 v86, v86
    v_rcp_f32 v87, v87
    v_rcp_f32 v88, v88
    v_rcp_f32 v89, v89
    s_waitcnt lgkmcnt(15)
    v_smfmac_f32_32x32x32_bf16 v[64:79], v[250:253], v[164:171], v254
    v_rcp_f32 v90, v90
    v_rcp_f32 v91, v91
    v_rcp_f32 v92, v92
    v_rcp_f32 v93, v93
    v_rcp_f32 v94, v94
    v_rcp_f32 v95, v95
    s_setprio 0
    v_mul_f32 v112, v80, v112
    v_mul_f32 v113, v81, v113
    v_mul_f32 v114, v82, v114
    v_mul_f32 v115, v83, v115
    v_mul_f32 v116, v84, v116
    v_mul_f32 v117, v85, v117
    v_mul_f32 v118, v86, v118
    v_mul_f32 v119, v87, v119
    v_mul_f32 v120, v88, v120
    v_mul_f32 v121, v89, v121
    v_mul_f32 v122, v90, v122
    v_mul_f32 v123, v91, v123
    v_mul_f32 v124, v92, v124
    v_mul_f32 v125, v93, v125
    v_mul_f32 v126, v94, v126
    v_mul_f32 v127, v95, v127
    s_setprio 3
    v_cvt_pk_bf16_f32 v128, v80, v81
    v_cvt_pk_bf16_f32 v136, v112, v113
    v_cvt_pk_bf16_f32 v129, v82, v83
    v_cvt_pk_bf16_f32 v137, v114, v115
    s_waitcnt lgkmcnt(13)
    v_mfma_f32_32x32x16_bf16 v[96:111], v[156:159], v[172:175], 0
    v_cvt_pk_bf16_f32 v130, v84, v85
    v_cvt_pk_bf16_f32 v138, v116, v117
    v_cvt_pk_bf16_f32 v131, v86, v87
    v_cvt_pk_bf16_f32 v139, v118, v119
    v_cvt_pk_bf16_f32 v132, v88, v89
    v_cvt_pk_bf16_f32 v140, v120, v121
    v_cvt_pk_bf16_f32 v133, v90, v91
    v_cvt_pk_bf16_f32 v141, v122, v123
    s_waitcnt lgkmcnt(10)
    v_mfma_f32_32x32x16_bf16 v[96:111], v[160:163], v[176:179], v[96:111]
    v_cvt_pk_bf16_f32 v134, v92, v93
    v_cvt_pk_bf16_f32 v142, v124, v125
    v_cvt_pk_bf16_f32 v135, v94, v95
    v_cvt_pk_bf16_f32 v143, v126, v127
    s_sub_u32 s67, s67, 1
    s_cmp_eq_u32 s67, 0
    s_cbranch_scc1 L_exit1
    s_waitcnt lgkmcnt(0)
    s_waitcnt vmcnt(5)
    v_bitop3_b32 v16, v16, v240, 62 bitop3:0x28
    v_add_u32 v16, v241, v16
    ds_write_b16 v16, v13
    ds_read_b128 v[180:183], v7
    ds_read_b128 v[184:187], v8
    ds_read_b64_tr_b16 v[164:165], v11 offset:32768
    ds_read_b64_tr_b16 v[166:167], v11 offset:33792
    ds_read_b64_tr_b16 v[168:169], v11 offset:34816
    ds_read_b64_tr_b16 v[170:171], v11 offset:35840
    ds_read_b64_tr_b16 v[172:173], v12 offset:32768
    ds_read_b64_tr_b16 v[174:175], v12 offset:33792
    s_add_u32 m0, s64, 0
    ds_read_b64_tr_b16 v[176:177], v12 offset:34816
    buffer_load_dwordx4 v[22:23], s[44:47], 0 idxen offen lds
    ds_read_u16 v22, v4 offset:9856
    s_add_u32 m0, s64, 1024
    ds_read_b64_tr_b16 v[178:179], v12 offset:35840
    buffer_load_dwordx4 v[24:25], s[44:47], 0 idxen offen lds
    ds_read_u16 v24, v4 offset:9872
    s_setprio 1
    v_mfma_f32_32x32x16_bf16 v[32:47], v[128:131], v[196:199], v[32:47]
    v_exp_f32 v64, v64
    v_exp_f32 v65, v65
    v_exp_f32 v66, v66
    v_exp_f32 v67, v67
    v_mfma_f32_32x32x16_bf16 v[48:63], v[136:139], v[196:199], v[48:63]
    v_exp_f32 v68, v68
    v_exp_f32 v69, v69
    v_exp_f32 v70, v70
    v_exp_f32 v71, v71
    v_mfma_f32_32x32x16_bf16 v[32:47], v[132:135], v[200:203], v[32:47]
    v_exp_f32 v72, v72
    v_exp_f32 v73, v73
    v_exp_f32 v74, v74
    v_exp_f32 v75, v75
    v_mfma_f32_32x32x16_bf16 v[48:63], v[140:143], v[200:203], v[48:63]
    v_exp_f32 v76, v76
    v_exp_f32 v77, v77
    v_exp_f32 v78, v78
    v_exp_f32 v79, v79
    s_setprio 0
    v_add_f32 v64, 1.0, v64
    v_add_f32 v65, 1.0, v65
    v_add_f32 v66, 1.0, v66
    v_add_f32 v67, 1.0, v67
    v_add_f32 v68, 1.0, v68
    v_add_f32 v69, 1.0, v69
    v_add_f32 v70, 1.0, v70
    v_add_f32 v71, 1.0, v71
    v_add_f32 v72, 1.0, v72
    v_add_f32 v73, 1.0, v73
    v_add_f32 v74, 1.0, v74
    v_add_f32 v75, 1.0, v75
    v_add_f32 v76, 1.0, v76
    v_add_f32 v77, 1.0, v77
    v_add_f32 v78, 1.0, v78
    v_add_f32 v79, 1.0, v79
    ds_read_b64_tr_b16 v[196:197], v9 offset:0
    ds_read_b64_tr_b16 v[198:199], v10 offset:512
    ds_read_b64_tr_b16 v[200:201], v9 offset:1024
    s_add_u32 m0, s64, 2048
    ds_read_b64_tr_b16 v[202:203], v10 offset:1536
    buffer_load_dwordx4 v[26:27], s[44:47], 0 idxen offen lds
    ds_read_u16 v26, v4 offset:9888
    s_add_u32 m0, s64, 3072
    ds_write_b16 v16, v14
    buffer_load_dwordx4 v[28:29], s[44:47], 0 idxen offen lds
    ds_read_u16 v28, v4 offset:9904
    buffer_load_dwordx4 v[204:207], v[20:21], s[48:51], 0 idxen offen
    ds_read_b32 v20, v5 offset:1280
    ds_read_u16 v15, v6 offset:14336
    s_setprio 1
    v_mfma_f32_32x32x16_bf16 v[80:95], v[208:211], v[152:155], 0
    v_rcp_f32 v64, v64
    v_rcp_f32 v65, v65
    v_rcp_f32 v66, v66
    s_waitcnt lgkmcnt(15)
    v_mfma_f32_32x32x16_bf16 v[80:95], v[180:183], v[144:147], v[80:95]
    v_rcp_f32 v67, v67
    v_rcp_f32 v68, v68
    v_rcp_f32 v69, v69
    s_waitcnt lgkmcnt(15)
    v_mfma_f32_32x32x16_bf16 v[80:95], v[184:187], v[148:151], v[80:95]
    v_rcp_f32 v70, v70
    v_rcp_f32 v71, v71
    v_rcp_f32 v72, v72
    v_rcp_f32 v73, v73
    s_waitcnt lgkmcnt(15)
    v_smfmac_f32_32x32x32_bf16 v[80:95], v[250:253], v[164:171], v254
    v_rcp_f32 v74, v74
    v_rcp_f32 v75, v75
    v_rcp_f32 v76, v76
    v_rcp_f32 v77, v77
    v_rcp_f32 v78, v78
    v_rcp_f32 v79, v79
    s_setprio 0
    v_mul_f32 v96, v64, v96
    v_mul_f32 v97, v65, v97
    v_mul_f32 v98, v66, v98
    v_mul_f32 v99, v67, v99
    v_mul_f32 v100, v68, v100
    v_mul_f32 v101, v69, v101
    v_mul_f32 v102, v70, v102
    v_mul_f32 v103, v71, v103
    v_mul_f32 v104, v72, v104
    v_mul_f32 v105, v73, v105
    v_mul_f32 v106, v74, v106
    v_mul_f32 v107, v75, v107
    v_mul_f32 v108, v76, v108
    v_mul_f32 v109, v77, v109
    v_mul_f32 v110, v78, v110
    v_mul_f32 v111, v79, v111
    s_setprio 3
    v_cvt_pk_bf16_f32 v128, v64, v65
    v_cvt_pk_bf16_f32 v136, v96, v97
    v_cvt_pk_bf16_f32 v129, v66, v67
    v_cvt_pk_bf16_f32 v137, v98, v99
    s_waitcnt lgkmcnt(13)
    v_mfma_f32_32x32x16_bf16 v[112:127], v[156:159], v[172:175], 0
    v_cvt_pk_bf16_f32 v130, v68, v69
    v_cvt_pk_bf16_f32 v138, v100, v101
    v_cvt_pk_bf16_f32 v131, v70, v71
    v_cvt_pk_bf16_f32 v139, v102, v103
    v_cvt_pk_bf16_f32 v132, v72, v73
    v_cvt_pk_bf16_f32 v140, v104, v105
    v_cvt_pk_bf16_f32 v133, v74, v75
    v_cvt_pk_bf16_f32 v141, v106, v107
    s_waitcnt lgkmcnt(10)
    v_mfma_f32_32x32x16_bf16 v[112:127], v[160:163], v[176:179], v[112:127]
    v_cvt_pk_bf16_f32 v134, v76, v77
    v_cvt_pk_bf16_f32 v142, v108, v109
    v_cvt_pk_bf16_f32 v135, v78, v79
    v_cvt_pk_bf16_f32 v143, v110, v111
    v_add_u32 v4, 384, v4
    v_add_u32 v5, 768, v5
    v_add_u32 v6, 384, v6
    s_sub_u32 s67, s67, 1
    s_cmp_lg_u32 s67, 0
    s_cbranch_scc1 L_loopF
    s_branch L_exit0
L_exit1:
    s_setprio 0
    s_nop 1
    v_mfma_f32_32x32x16_bf16 v[32:47], v[128:131], v[196:199], v[32:47]
    v_mfma_f32_32x32x16_bf16 v[48:63], v[136:139], v[196:199], v[48:63]
    v_mfma_f32_32x32x16_bf16 v[32:47], v[132:135], v[200:203], v[32:47]
    v_mfma_f32_32x32x16_bf16 v[48:63], v[140:143], v[200:203], v[48:63]
    s_branch L_round_end
L_exit0:
    s_setprio 0
    s_nop 1
    v_mfma_f32_32x32x16_bf16 v[32:47], v[128:131], v[188:191], v[32:47]
    v_mfma_f32_32x32x16_bf16 v[48:63], v[136:139], v[188:191], v[48:63]
    v_mfma_f32_32x32x16_bf16 v[32:47], v[132:135], v[192:195], v[32:47]
    v_mfma_f32_32x32x16_bf16 v[48:63], v[140:143], v[192:195], v[48:63]
L_round_end:
    s_add_u32 s62, s62, 1
    s_cmp_lt_u32 s62, s63
    s_cbranch_scc1 L_next_round
    v_add_u32 v17, s70, v2
    v_and_b32 v18, 15, v17
    s_lshl_b32 s11, s7, 2
    v_xor_b32 v18, s11, v18
    v_lshlrev_b32 v18, 4, v18
    v_lshl_add_u32 v17, v17, 8, v18
    v_lshl_add_u32 v17, v3, 3, v17
    v_add_u32 v17, 137472, v17
    v_xor_b32 v18, 0, v17
    ds_read_b64 v[128:129], v18
    v_xor_b32 v18, 16, v17
    ds_read_b64 v[130:131], v18
    v_xor_b32 v18, 32, v17
    ds_read_b64 v[132:133], v18
    v_xor_b32 v18, 48, v17
    ds_read_b64 v[134:135], v18
    v_cmp_gt_u32 vcc, s10, v2
    v_add_u32 v17, s9, v2
    v_lshlrev_b32 v17, 8, v17
    v_lshl_add_u32 v17, v3, 4, v17
    s_lshl_b32 s11, s7, 6
    v_add_u32 v17, s11, v17
    v_bfrev_b32 v18, 1
    v_cndmask_b32 v17, v18, v17, vcc
    s_mov_b32 s12, 0x358637bd
    s_mov_b32 s13, 0x358637bd
    v_pk_add_f32 v[32:33], v[32:33], s[12:13]
    v_pk_add_f32 v[34:35], v[34:35], s[12:13]
    v_pk_add_f32 v[36:37], v[36:37], s[12:13]
    v_pk_add_f32 v[38:39], v[38:39], s[12:13]
    v_pk_add_f32 v[40:41], v[40:41], s[12:13]
    v_pk_add_f32 v[42:43], v[42:43], s[12:13]
    v_pk_add_f32 v[44:45], v[44:45], s[12:13]
    v_pk_add_f32 v[46:47], v[46:47], s[12:13]
    v_rcp_f32 v32, v32
    v_rcp_f32 v33, v33
    v_rcp_f32 v34, v34
    v_rcp_f32 v35, v35
    v_rcp_f32 v36, v36
    v_rcp_f32 v37, v37
    v_rcp_f32 v38, v38
    v_rcp_f32 v39, v39
    v_rcp_f32 v40, v40
    v_rcp_f32 v41, v41
    v_rcp_f32 v42, v42
    v_rcp_f32 v43, v43
    v_rcp_f32 v44, v44
    v_rcp_f32 v45, v45
    v_rcp_f32 v46, v46
    v_rcp_f32 v47, v47
    v_pk_fma_f32 v[48:49], v[48:49], v[32:33], v[212:213]
    v_pk_fma_f32 v[50:51], v[50:51], v[34:35], v[214:215]
    v_pk_fma_f32 v[52:53], v[52:53], v[36:37], v[216:217]
    v_pk_fma_f32 v[54:55], v[54:55], v[38:39], v[218:219]
    v_pk_fma_f32 v[56:57], v[56:57], v[40:41], v[220:221]
    v_pk_fma_f32 v[58:59], v[58:59], v[42:43], v[222:223]
    v_pk_fma_f32 v[60:61], v[60:61], v[44:45], v[224:225]
    v_pk_fma_f32 v[62:63], v[62:63], v[46:47], v[226:227]
    v_max_f32 v48, 0, v48
    v_max_f32 v49, 0, v49
    v_max_f32 v50, 0, v50
    v_max_f32 v51, 0, v51
    v_max_f32 v52, 0, v52
    v_max_f32 v53, 0, v53
    v_max_f32 v54, 0, v54
    v_max_f32 v55, 0, v55
    v_max_f32 v56, 0, v56
    v_max_f32 v57, 0, v57
    v_max_f32 v58, 0, v58
    v_max_f32 v59, 0, v59
    v_max_f32 v60, 0, v60
    v_max_f32 v61, 0, v61
    v_max_f32 v62, 0, v62
    v_max_f32 v63, 0, v63
    s_waitcnt lgkmcnt(0)
    v_lshlrev_b32 v32, 16, v128
    v_and_b32 v33, 0xffff0000, v128
    v_lshlrev_b32 v34, 16, v129
    v_and_b32 v35, 0xffff0000, v129
    v_lshlrev_b32 v36, 16, v130
    v_and_b32 v37, 0xffff0000, v130
    v_lshlrev_b32 v38, 16, v131
    v_and_b32 v39, 0xffff0000, v131
    v_lshlrev_b32 v40, 16, v132
    v_and_b32 v41, 0xffff0000, v132
    v_lshlrev_b32 v42, 16, v133
    v_and_b32 v43, 0xffff0000, v133
    v_lshlrev_b32 v44, 16, v134
    v_and_b32 v45, 0xffff0000, v134
    v_lshlrev_b32 v46, 16, v135
    v_and_b32 v47, 0xffff0000, v135
    v_pk_add_f32 v[48:49], v[48:49], v[32:33]
    v_pk_add_f32 v[50:51], v[50:51], v[34:35]
    v_pk_add_f32 v[52:53], v[52:53], v[36:37]
    v_pk_add_f32 v[54:55], v[54:55], v[38:39]
    v_pk_add_f32 v[56:57], v[56:57], v[40:41]
    v_pk_add_f32 v[58:59], v[58:59], v[42:43]
    v_pk_add_f32 v[60:61], v[60:61], v[44:45]
    v_pk_add_f32 v[62:63], v[62:63], v[46:47]
    v_cvt_pk_bf16_f32 v136, v48, v49
    v_cvt_pk_bf16_f32 v137, v50, v51
    v_cvt_pk_bf16_f32 v138, v52, v53
    v_cvt_pk_bf16_f32 v139, v54, v55
    v_cvt_pk_bf16_f32 v140, v56, v57
    v_cvt_pk_bf16_f32 v141, v58, v59
    v_cvt_pk_bf16_f32 v142, v60, v61
    v_cvt_pk_bf16_f32 v143, v62, v63
    v_permlane32_swap_b32 v136, v138
    v_permlane32_swap_b32 v137, v139
    v_permlane32_swap_b32 v140, v142
    v_permlane32_swap_b32 v141, v143
    buffer_store_dwordx4 v[136:139], v17, s[56:59], 0 offen offset:0
    buffer_store_dwordx4 v[140:143], v17, s[56:59], 0 offen offset:32
    s_endpgm
L_slow0:
    v_and_b32 v17, 48, v1
    v_lshlrev_b32 v17, 4, v17
    s_lshl_b32 s11, s3, 5
    v_add_u32 v17, s11, v17
    s_lshl_b32 s11, s4, 11
    s_add_u32 s11, s11, 12977160
    buffer_load_ushort v232, v17, s[52:55], s11 offen offset:0
    buffer_load_ushort v233, v17, s[52:55], s11 offen offset:1024
    buffer_load_ushort v234, v17, s[52:55], s11 offen offset:16
    buffer_load_ushort v235, v17, s[52:55], s11 offen offset:1040
    s_waitcnt vmcnt(0)
    v_and_b32 v192, 15, v1
    v_mov_b32 v193, 0x20000000
    v_lshlrev_b32 v17, 3, v239
    v_lshl_add_u32 v17, v192, 3, v17
    s_lshl_b32 s15, s4, 14
    s_add_u32 s15, s15, 10880000
    buffer_load_dwordx2 v[64:65], v17, s[52:55], s15 offen offset:0
    buffer_load_dwordx2 v[66:67], v17, s[52:55], s15 offen offset:512
    buffer_load_dwordx2 v[68:69], v17, s[52:55], s15 offen offset:1024
    buffer_load_dwordx2 v[70:71], v17, s[52:55], s15 offen offset:1536
    v_add_u32 v17, v238, v192
    v_add_u32 v72, v228, v17
    v_add_u32 v76, 16, v72
    v_add_u32 v73, v229, v17
    v_add_u32 v73, 5120, v73
    v_add_u32 v77, 16, v73
    v_add_u32 v74, v230, v17
    v_add_u32 v74, 10240, v74
    v_add_u32 v78, 16, v74
    v_add_u32 v75, v231, v17
    v_add_u32 v75, 15360, v75
    v_add_u32 v79, 16, v75
    s_waitcnt vmcnt(0)
    v_cmp_ne_u32 vcc, -1, v64
    s_nop 1
    v_cndmask_b32 v72, v193, v72, vcc
    v_cmp_ne_u32 vcc, -1, v66
    s_nop 1
    v_cndmask_b32 v73, v193, v73, vcc
    v_cmp_ne_u32 vcc, -1, v68
    s_nop 1
    v_cndmask_b32 v74, v193, v74, vcc
    v_cmp_ne_u32 vcc, -1, v70
    s_nop 1
    v_cndmask_b32 v75, v193, v75, vcc
    v_cmp_ne_u32 vcc, -1, v65
    s_nop 1
    v_cndmask_b32 v76, v193, v76, vcc
    v_cmp_ne_u32 vcc, -1, v67
    s_nop 1
    v_cndmask_b32 v77, v193, v77, vcc
    v_cmp_ne_u32 vcc, -1, v69
    s_nop 1
    v_cndmask_b32 v78, v193, v78, vcc
    v_cmp_ne_u32 vcc, -1, v71
    s_nop 1
    v_cndmask_b32 v79, v193, v79, vcc
    s_waitcnt vmcnt(0)
    v_bfe_u32 v172, v64, 22, 2
    v_lshl_add_u32 v17, v172, 2, v239
    ds_read_b32 v164, v17 offset:18432
    v_bfe_u32 v173, v66, 22, 2
    v_lshl_add_u32 v17, v173, 2, v239
    ds_read_b32 v165, v17 offset:18496
    v_bfe_u32 v174, v68, 22, 2
    v_lshl_add_u32 v17, v174, 2, v239
    ds_read_b32 v166, v17 offset:18560
    v_bfe_u32 v175, v70, 22, 2
    v_lshl_add_u32 v17, v175, 2, v239
    ds_read_b32 v167, v17 offset:18624
    v_bfe_u32 v176, v65, 22, 2
    v_lshl_add_u32 v17, v176, 2, v239
    ds_read_b32 v168, v17 offset:18432
    v_bfe_u32 v177, v67, 22, 2
    v_lshl_add_u32 v17, v177, 2, v239
    ds_read_b32 v169, v17 offset:18496
    v_bfe_u32 v178, v69, 22, 2
    v_lshl_add_u32 v17, v178, 2, v239
    ds_read_b32 v170, v17 offset:18560
    v_bfe_u32 v179, v71, 22, 2
    v_lshl_add_u32 v17, v179, 2, v239
    ds_read_b32 v171, v17 offset:18624
    s_waitcnt lgkmcnt(0)
    v_sub_u32 v17, v72, v238
    v_sub_u32 v17, v17, v228
    v_add_u32 v164, v17, v164
    v_mad_i32_i24 v17, v172, s68, v164
    v_cmp_gt_u32 vcc, s69, v17
    s_cbranch_vccz L_pl_sp_0
    v_lshlrev_b32 v17, 2, v164
    v_lshlrev_b32 v18, 1, v164
    s_mov_b64 exec, vcc
    ds_write_b32 v17, v72 offset:0
    ds_write_b16 v18, v64 offset:9216
    ds_write_b16_d16_hi v18, v64 offset:13824
    s_mov_b64 exec, -1
L_pl_sp_0:
    v_sub_u32 v17, v73, v238
    v_subrev_u32 v17, 5120, v17
    v_sub_u32 v17, v17, v229
    v_add_u32 v165, v17, v165
    v_mad_i32_i24 v17, v173, s68, v165
    v_cmp_gt_u32 vcc, s69, v17
    s_cbranch_vccz L_pl_sp_1
    v_lshlrev_b32 v17, 2, v165
    v_lshlrev_b32 v18, 1, v165
    s_mov_b64 exec, vcc
    ds_write_b32 v17, v73 offset:0
    ds_write_b16 v18, v66 offset:9216
    ds_write_b16_d16_hi v18, v66 offset:13824
    s_mov_b64 exec, -1
L_pl_sp_1:
    v_sub_u32 v17, v74, v238
    v_subrev_u32 v17, 10240, v17
    v_sub_u32 v17, v17, v230
    v_add_u32 v166, v17, v166
    v_mad_i32_i24 v17, v174, s68, v166
    v_cmp_gt_u32 vcc, s69, v17
    s_cbranch_vccz L_pl_sp_2
    v_lshlrev_b32 v17, 2, v166
    v_lshlrev_b32 v18, 1, v166
    s_mov_b64 exec, vcc
    ds_write_b32 v17, v74 offset:0
    ds_write_b16 v18, v68 offset:9216
    ds_write_b16_d16_hi v18, v68 offset:13824
    s_mov_b64 exec, -1
L_pl_sp_2:
    v_sub_u32 v17, v75, v238
    v_subrev_u32 v17, 15360, v17
    v_sub_u32 v17, v17, v231
    v_add_u32 v167, v17, v167
    v_mad_i32_i24 v17, v175, s68, v167
    v_cmp_gt_u32 vcc, s69, v17
    s_cbranch_vccz L_pl_sp_3
    v_lshlrev_b32 v17, 2, v167
    v_lshlrev_b32 v18, 1, v167
    s_mov_b64 exec, vcc
    ds_write_b32 v17, v75 offset:0
    ds_write_b16 v18, v70 offset:9216
    ds_write_b16_d16_hi v18, v70 offset:13824
    s_mov_b64 exec, -1
L_pl_sp_3:
    v_sub_u32 v17, v76, v238
    v_sub_u32 v17, v17, v228
    v_add_u32 v168, v17, v168
    v_mad_i32_i24 v17, v176, s68, v168
    v_cmp_gt_u32 vcc, s69, v17
    s_cbranch_vccz L_pl_sp_4
    v_lshlrev_b32 v17, 2, v168
    v_lshlrev_b32 v18, 1, v168
    s_mov_b64 exec, vcc
    ds_write_b32 v17, v76 offset:0
    ds_write_b16 v18, v65 offset:9216
    ds_write_b16_d16_hi v18, v65 offset:13824
    s_mov_b64 exec, -1
L_pl_sp_4:
    v_sub_u32 v17, v77, v238
    v_subrev_u32 v17, 5120, v17
    v_sub_u32 v17, v17, v229
    v_add_u32 v169, v17, v169
    v_mad_i32_i24 v17, v177, s68, v169
    v_cmp_gt_u32 vcc, s69, v17
    s_cbranch_vccz L_pl_sp_5
    v_lshlrev_b32 v17, 2, v169
    v_lshlrev_b32 v18, 1, v169
    s_mov_b64 exec, vcc
    ds_write_b32 v17, v77 offset:0
    ds_write_b16 v18, v67 offset:9216
    ds_write_b16_d16_hi v18, v67 offset:13824
    s_mov_b64 exec, -1
L_pl_sp_5:
    v_sub_u32 v17, v78, v238
    v_subrev_u32 v17, 10240, v17
    v_sub_u32 v17, v17, v230
    v_add_u32 v170, v17, v170
    v_mad_i32_i24 v17, v178, s68, v170
    v_cmp_gt_u32 vcc, s69, v17
    s_cbranch_vccz L_pl_sp_6
    v_lshlrev_b32 v17, 2, v170
    v_lshlrev_b32 v18, 1, v170
    s_mov_b64 exec, vcc
    ds_write_b32 v17, v78 offset:0
    ds_write_b16 v18, v69 offset:9216
    ds_write_b16_d16_hi v18, v69 offset:13824
    s_mov_b64 exec, -1
L_pl_sp_6:
    v_sub_u32 v17, v79, v238
    v_subrev_u32 v17, 15360, v17
    v_sub_u32 v17, v17, v231
    v_add_u32 v171, v17, v171
    v_mad_i32_i24 v17, v179, s68, v171
    v_cmp_gt_u32 vcc, s69, v17
    s_cbranch_vccz L_pl_sp_7
    v_lshlrev_b32 v17, 2, v171
    v_lshlrev_b32 v18, 1, v171
    s_mov_b64 exec, vcc
    ds_write_b32 v17, v79 offset:0
    ds_write_b16 v18, v71 offset:9216
    ds_write_b16_d16_hi v18, v71 offset:13824
    s_mov_b64 exec, -1
L_pl_sp_7:
    s_mov_b32 s15, 10240000
    v_add3_u32 v188, v228, v192, 32
    v_add3_u32 v189, v229, v192, 32
    v_add3_u32 v190, v230, v192, 32
    v_add3_u32 v191, v231, v192, 32
L_more_s:
    v_cmp_lt_u32 s[12:13], v188, v232
    v_cmp_lt_u32 vcc, v189, v233
    s_nop 0
    s_or_b64 s[12:13], s[12:13], vcc
    v_cmp_lt_u32 vcc, v190, v234
    s_nop 0
    s_or_b64 s[12:13], s[12:13], vcc
    v_cmp_lt_u32 vcc, v191, v235
    s_nop 0
    s_or_b64 s[12:13], s[12:13], vcc
    s_cmp_eq_u64 s[12:13], 0
    s_cbranch_scc1 L_done_s
    v_cmp_lt_u32 vcc, v188, v232
    v_add_u32 v72, v188, v238
    s_nop 0
    v_cndmask_b32 v72, v193, v72, vcc
    v_lshlrev_b32 v18, 2, v72
    buffer_load_dword v64, v18, s[52:55], s15 offen
    v_cmp_lt_u32 vcc, v189, v233
    v_add_u32 v73, v189, v238
    v_add_u32 v73, 5120, v73
    v_cndmask_b32 v73, v193, v73, vcc
    v_lshlrev_b32 v18, 2, v73
    buffer_load_dword v66, v18, s[52:55], s15 offen
    v_cmp_lt_u32 vcc, v190, v234
    v_add_u32 v74, v190, v238
    v_add_u32 v74, 10240, v74
    v_cndmask_b32 v74, v193, v74, vcc
    v_lshlrev_b32 v18, 2, v74
    buffer_load_dword v68, v18, s[52:55], s15 offen
    v_cmp_lt_u32 vcc, v191, v235
    v_add_u32 v75, v191, v238
    v_add_u32 v75, 15360, v75
    v_cndmask_b32 v75, v193, v75, vcc
    v_lshlrev_b32 v18, 2, v75
    buffer_load_dword v70, v18, s[52:55], s15 offen
    v_add_u32 v17, 16, v188
    v_cmp_lt_u32 vcc, v17, v232
    v_add_u32 v76, v17, v238
    s_nop 0
    v_cndmask_b32 v76, v193, v76, vcc
    v_lshlrev_b32 v18, 2, v76
    buffer_load_dword v65, v18, s[52:55], s15 offen
    v_add_u32 v17, 16, v189
    v_cmp_lt_u32 vcc, v17, v233
    v_add_u32 v77, v17, v238
    v_add_u32 v77, 5120, v77
    v_cndmask_b32 v77, v193, v77, vcc
    v_lshlrev_b32 v18, 2, v77
    buffer_load_dword v67, v18, s[52:55], s15 offen
    v_add_u32 v17, 16, v190
    v_cmp_lt_u32 vcc, v17, v234
    v_add_u32 v78, v17, v238
    v_add_u32 v78, 10240, v78
    v_cndmask_b32 v78, v193, v78, vcc
    v_lshlrev_b32 v18, 2, v78
    buffer_load_dword v69, v18, s[52:55], s15 offen
    v_add_u32 v17, 16, v191
    v_cmp_lt_u32 vcc, v17, v235
    v_add_u32 v79, v17, v238
    v_add_u32 v79, 15360, v79
    v_cndmask_b32 v79, v193, v79, vcc
    v_lshlrev_b32 v18, 2, v79
    buffer_load_dword v71, v18, s[52:55], s15 offen
    s_waitcnt vmcnt(0)
    v_bfe_u32 v172, v64, 22, 2
    v_lshl_add_u32 v17, v172, 2, v239
    ds_read_b32 v164, v17 offset:18432
    v_bfe_u32 v173, v66, 22, 2
    v_lshl_add_u32 v17, v173, 2, v239
    ds_read_b32 v165, v17 offset:18496
    v_bfe_u32 v174, v68, 22, 2
    v_lshl_add_u32 v17, v174, 2, v239
    ds_read_b32 v166, v17 offset:18560
    v_bfe_u32 v175, v70, 22, 2
    v_lshl_add_u32 v17, v175, 2, v239
    ds_read_b32 v167, v17 offset:18624
    v_bfe_u32 v176, v65, 22, 2
    v_lshl_add_u32 v17, v176, 2, v239
    ds_read_b32 v168, v17 offset:18432
    v_bfe_u32 v177, v67, 22, 2
    v_lshl_add_u32 v17, v177, 2, v239
    ds_read_b32 v169, v17 offset:18496
    v_bfe_u32 v178, v69, 22, 2
    v_lshl_add_u32 v17, v178, 2, v239
    ds_read_b32 v170, v17 offset:18560
    v_bfe_u32 v179, v71, 22, 2
    v_lshl_add_u32 v17, v179, 2, v239
    ds_read_b32 v171, v17 offset:18624
    s_waitcnt lgkmcnt(0)
    v_sub_u32 v17, v72, v238
    v_sub_u32 v17, v17, v228
    v_add_u32 v164, v17, v164
    v_mad_i32_i24 v17, v172, s68, v164
    v_cmp_gt_u32 vcc, s69, v17
    s_cbranch_vccz L_pl_s_0
    v_lshlrev_b32 v17, 2, v164
    v_lshlrev_b32 v18, 1, v164
    s_mov_b64 exec, vcc
    ds_write_b32 v17, v72 offset:0
    ds_write_b16 v18, v64 offset:9216
    ds_write_b16_d16_hi v18, v64 offset:13824
    s_mov_b64 exec, -1
L_pl_s_0:
    v_sub_u32 v17, v73, v238
    v_subrev_u32 v17, 5120, v17
    v_sub_u32 v17, v17, v229
    v_add_u32 v165, v17, v165
    v_mad_i32_i24 v17, v173, s68, v165
    v_cmp_gt_u32 vcc, s69, v17
    s_cbranch_vccz L_pl_s_1
    v_lshlrev_b32 v17, 2, v165
    v_lshlrev_b32 v18, 1, v165
    s_mov_b64 exec, vcc
    ds_write_b32 v17, v73 offset:0
    ds_write_b16 v18, v66 offset:9216
    ds_write_b16_d16_hi v18, v66 offset:13824
    s_mov_b64 exec, -1
L_pl_s_1:
    v_sub_u32 v17, v74, v238
    v_subrev_u32 v17, 10240, v17
    v_sub_u32 v17, v17, v230
    v_add_u32 v166, v17, v166
    v_mad_i32_i24 v17, v174, s68, v166
    v_cmp_gt_u32 vcc, s69, v17
    s_cbranch_vccz L_pl_s_2
    v_lshlrev_b32 v17, 2, v166
    v_lshlrev_b32 v18, 1, v166
    s_mov_b64 exec, vcc
    ds_write_b32 v17, v74 offset:0
    ds_write_b16 v18, v68 offset:9216
    ds_write_b16_d16_hi v18, v68 offset:13824
    s_mov_b64 exec, -1
L_pl_s_2:
    v_sub_u32 v17, v75, v238
    v_subrev_u32 v17, 15360, v17
    v_sub_u32 v17, v17, v231
    v_add_u32 v167, v17, v167
    v_mad_i32_i24 v17, v175, s68, v167
    v_cmp_gt_u32 vcc, s69, v17
    s_cbranch_vccz L_pl_s_3
    v_lshlrev_b32 v17, 2, v167
    v_lshlrev_b32 v18, 1, v167
    s_mov_b64 exec, vcc
    ds_write_b32 v17, v75 offset:0
    ds_write_b16 v18, v70 offset:9216
    ds_write_b16_d16_hi v18, v70 offset:13824
    s_mov_b64 exec, -1
L_pl_s_3:
    v_sub_u32 v17, v76, v238
    v_sub_u32 v17, v17, v228
    v_add_u32 v168, v17, v168
    v_mad_i32_i24 v17, v176, s68, v168
    v_cmp_gt_u32 vcc, s69, v17
    s_cbranch_vccz L_pl_s_4
    v_lshlrev_b32 v17, 2, v168
    v_lshlrev_b32 v18, 1, v168
    s_mov_b64 exec, vcc
    ds_write_b32 v17, v76 offset:0
    ds_write_b16 v18, v65 offset:9216
    ds_write_b16_d16_hi v18, v65 offset:13824
    s_mov_b64 exec, -1
L_pl_s_4:
    v_sub_u32 v17, v77, v238
    v_subrev_u32 v17, 5120, v17
    v_sub_u32 v17, v17, v229
    v_add_u32 v169, v17, v169
    v_mad_i32_i24 v17, v177, s68, v169
    v_cmp_gt_u32 vcc, s69, v17
    s_cbranch_vccz L_pl_s_5
    v_lshlrev_b32 v17, 2, v169
    v_lshlrev_b32 v18, 1, v169
    s_mov_b64 exec, vcc
    ds_write_b32 v17, v77 offset:0
    ds_write_b16 v18, v67 offset:9216
    ds_write_b16_d16_hi v18, v67 offset:13824
    s_mov_b64 exec, -1
L_pl_s_5:
    v_sub_u32 v17, v78, v238
    v_subrev_u32 v17, 10240, v17
    v_sub_u32 v17, v17, v230
    v_add_u32 v170, v17, v170
    v_mad_i32_i24 v17, v178, s68, v170
    v_cmp_gt_u32 vcc, s69, v17
    s_cbranch_vccz L_pl_s_6
    v_lshlrev_b32 v17, 2, v170
    v_lshlrev_b32 v18, 1, v170
    s_mov_b64 exec, vcc
    ds_write_b32 v17, v78 offset:0
    ds_write_b16 v18, v69 offset:9216
    ds_write_b16_d16_hi v18, v69 offset:13824
    s_mov_b64 exec, -1
L_pl_s_6:
    v_sub_u32 v17, v79, v238
    v_subrev_u32 v17, 15360, v17
    v_sub_u32 v17, v17, v231
    v_add_u32 v171, v17, v171
    v_mad_i32_i24 v17, v179, s68, v171
    v_cmp_gt_u32 vcc, s69, v17
    s_cbranch_vccz L_pl_s_7
    v_lshlrev_b32 v17, 2, v171
    v_lshlrev_b32 v18, 1, v171
    s_mov_b64 exec, vcc
    ds_write_b32 v17, v79 offset:0
    ds_write_b16 v18, v71 offset:9216
    ds_write_b16_d16_hi v18, v71 offset:13824
    s_mov_b64 exec, -1
L_pl_s_7:
    v_add_u32 v188, 32, v188
    v_add_u32 v189, 32, v189
    v_add_u32 v190, 32, v190
    v_add_u32 v191, 32, v191
    s_branch L_more_s
L_done_s:
    s_branch L_placed0
L_next_round:
    s_waitcnt vmcnt(0) lgkmcnt(0)
    s_barrier
    v_lshlrev_b32 v17, 4, v0
    v_mov_b32 v164, -1
    v_mov_b32 v165, -1
    v_mov_b32 v166, -1
    v_mov_b32 v167, -1
    ds_write_b128 v17, v[164:167] offset:0
    v_lshlrev_b32 v18, 3, v0
    ds_write_b64 v18, v[164:165] offset:9216
    v_mov_b32 v168, 0x3e003e
    v_mov_b32 v169, 0x3e003e
    ds_write_b64 v18, v[168:169] offset:13824
    v_lshlrev_b32 v17, 4, v1
    ds_write_b128 v17, v[164:167] offset:8192
    v_lshlrev_b32 v18, 3, v1
    ds_write_b64 v18, v[164:165] offset:13312
    ds_write_b64 v18, v[168:169] offset:17920
    v_subrev_u32 v236, 416, v236
    v_subrev_u32 v237, 416, v237
    v_and_b32 v17, 15, v1
    v_lshlrev_b32 v17, 7, v17
    v_and_b32 v18, 48, v1
    s_lshl_b32 s11, s73, 2
    v_add3_u32 v17, v17, v18, s11
    ds_write_b32 v17, v236 offset:18432
    ds_write_b32 v17, v237 offset:18496
    s_waitcnt lgkmcnt(0)
    s_barrier
    v_and_b32 v17, 48, v1
    v_lshlrev_b32 v17, 4, v17
    s_lshl_b32 s11, s3, 5
    v_add_u32 v17, s11, v17
    s_lshl_b32 s11, s4, 11
    s_add_u32 s11, s11, 12977160
    buffer_load_ushort v232, v17, s[52:55], s11 offen offset:0
    buffer_load_ushort v233, v17, s[52:55], s11 offen offset:1024
    buffer_load_ushort v234, v17, s[52:55], s11 offen offset:16
    buffer_load_ushort v235, v17, s[52:55], s11 offen offset:1040
    s_waitcnt vmcnt(0)
    v_and_b32 v192, 15, v1
    v_mov_b32 v193, 0x20000000
    v_lshlrev_b32 v17, 3, v239
    v_lshl_add_u32 v17, v192, 3, v17
    s_lshl_b32 s15, s4, 14
    s_add_u32 s15, s15, 10880000
    buffer_load_dwordx2 v[64:65], v17, s[52:55], s15 offen offset:0
    buffer_load_dwordx2 v[66:67], v17, s[52:55], s15 offen offset:512
    buffer_load_dwordx2 v[68:69], v17, s[52:55], s15 offen offset:1024
    buffer_load_dwordx2 v[70:71], v17, s[52:55], s15 offen offset:1536
    v_add_u32 v17, v238, v192
    v_add_u32 v72, v228, v17
    v_add_u32 v76, 16, v72
    v_add_u32 v73, v229, v17
    v_add_u32 v73, 5120, v73
    v_add_u32 v77, 16, v73
    v_add_u32 v74, v230, v17
    v_add_u32 v74, 10240, v74
    v_add_u32 v78, 16, v74
    v_add_u32 v75, v231, v17
    v_add_u32 v75, 15360, v75
    v_add_u32 v79, 16, v75
    s_waitcnt vmcnt(0)
    v_cmp_ne_u32 vcc, -1, v64
    s_nop 1
    v_cndmask_b32 v72, v193, v72, vcc
    v_cmp_ne_u32 vcc, -1, v66
    s_nop 1
    v_cndmask_b32 v73, v193, v73, vcc
    v_cmp_ne_u32 vcc, -1, v68
    s_nop 1
    v_cndmask_b32 v74, v193, v74, vcc
    v_cmp_ne_u32 vcc, -1, v70
    s_nop 1
    v_cndmask_b32 v75, v193, v75, vcc
    v_cmp_ne_u32 vcc, -1, v65
    s_nop 1
    v_cndmask_b32 v76, v193, v76, vcc
    v_cmp_ne_u32 vcc, -1, v67
    s_nop 1
    v_cndmask_b32 v77, v193, v77, vcc
    v_cmp_ne_u32 vcc, -1, v69
    s_nop 1
    v_cndmask_b32 v78, v193, v78, vcc
    v_cmp_ne_u32 vcc, -1, v71
    s_nop 1
    v_cndmask_b32 v79, v193, v79, vcc
    s_waitcnt vmcnt(0)
    v_bfe_u32 v172, v64, 22, 2
    v_lshl_add_u32 v17, v172, 2, v239
    ds_read_b32 v164, v17 offset:18432
    v_bfe_u32 v173, v66, 22, 2
    v_lshl_add_u32 v17, v173, 2, v239
    ds_read_b32 v165, v17 offset:18496
    v_bfe_u32 v174, v68, 22, 2
    v_lshl_add_u32 v17, v174, 2, v239
    ds_read_b32 v166, v17 offset:18560
    v_bfe_u32 v175, v70, 22, 2
    v_lshl_add_u32 v17, v175, 2, v239
    ds_read_b32 v167, v17 offset:18624
    v_bfe_u32 v176, v65, 22, 2
    v_lshl_add_u32 v17, v176, 2, v239
    ds_read_b32 v168, v17 offset:18432
    v_bfe_u32 v177, v67, 22, 2
    v_lshl_add_u32 v17, v177, 2, v239
    ds_read_b32 v169, v17 offset:18496
    v_bfe_u32 v178, v69, 22, 2
    v_lshl_add_u32 v17, v178, 2, v239
    ds_read_b32 v170, v17 offset:18560
    v_bfe_u32 v179, v71, 22, 2
    v_lshl_add_u32 v17, v179, 2, v239
    ds_read_b32 v171, v17 offset:18624
    s_waitcnt lgkmcnt(0)
    v_sub_u32 v17, v72, v238
    v_sub_u32 v17, v17, v228
    v_add_u32 v164, v17, v164
    v_mad_i32_i24 v17, v172, s68, v164
    v_cmp_gt_u32 vcc, s69, v17
    s_cbranch_vccz L_pl_rp_0
    v_lshlrev_b32 v17, 2, v164
    v_lshlrev_b32 v18, 1, v164
    s_mov_b64 exec, vcc
    ds_write_b32 v17, v72 offset:0
    ds_write_b16 v18, v64 offset:9216
    ds_write_b16_d16_hi v18, v64 offset:13824
    s_mov_b64 exec, -1
L_pl_rp_0:
    v_sub_u32 v17, v73, v238
    v_subrev_u32 v17, 5120, v17
    v_sub_u32 v17, v17, v229
    v_add_u32 v165, v17, v165
    v_mad_i32_i24 v17, v173, s68, v165
    v_cmp_gt_u32 vcc, s69, v17
    s_cbranch_vccz L_pl_rp_1
    v_lshlrev_b32 v17, 2, v165
    v_lshlrev_b32 v18, 1, v165
    s_mov_b64 exec, vcc
    ds_write_b32 v17, v73 offset:0
    ds_write_b16 v18, v66 offset:9216
    ds_write_b16_d16_hi v18, v66 offset:13824
    s_mov_b64 exec, -1
L_pl_rp_1:
    v_sub_u32 v17, v74, v238
    v_subrev_u32 v17, 10240, v17
    v_sub_u32 v17, v17, v230
    v_add_u32 v166, v17, v166
    v_mad_i32_i24 v17, v174, s68, v166
    v_cmp_gt_u32 vcc, s69, v17
    s_cbranch_vccz L_pl_rp_2
    v_lshlrev_b32 v17, 2, v166
    v_lshlrev_b32 v18, 1, v166
    s_mov_b64 exec, vcc
    ds_write_b32 v17, v74 offset:0
    ds_write_b16 v18, v68 offset:9216
    ds_write_b16_d16_hi v18, v68 offset:13824
    s_mov_b64 exec, -1
L_pl_rp_2:
    v_sub_u32 v17, v75, v238
    v_subrev_u32 v17, 15360, v17
    v_sub_u32 v17, v17, v231
    v_add_u32 v167, v17, v167
    v_mad_i32_i24 v17, v175, s68, v167
    v_cmp_gt_u32 vcc, s69, v17
    s_cbranch_vccz L_pl_rp_3
    v_lshlrev_b32 v17, 2, v167
    v_lshlrev_b32 v18, 1, v167
    s_mov_b64 exec, vcc
    ds_write_b32 v17, v75 offset:0
    ds_write_b16 v18, v70 offset:9216
    ds_write_b16_d16_hi v18, v70 offset:13824
    s_mov_b64 exec, -1
L_pl_rp_3:
    v_sub_u32 v17, v76, v238
    v_sub_u32 v17, v17, v228
    v_add_u32 v168, v17, v168
    v_mad_i32_i24 v17, v176, s68, v168
    v_cmp_gt_u32 vcc, s69, v17
    s_cbranch_vccz L_pl_rp_4
    v_lshlrev_b32 v17, 2, v168
    v_lshlrev_b32 v18, 1, v168
    s_mov_b64 exec, vcc
    ds_write_b32 v17, v76 offset:0
    ds_write_b16 v18, v65 offset:9216
    ds_write_b16_d16_hi v18, v65 offset:13824
    s_mov_b64 exec, -1
L_pl_rp_4:
    v_sub_u32 v17, v77, v238
    v_subrev_u32 v17, 5120, v17
    v_sub_u32 v17, v17, v229
    v_add_u32 v169, v17, v169
    v_mad_i32_i24 v17, v177, s68, v169
    v_cmp_gt_u32 vcc, s69, v17
    s_cbranch_vccz L_pl_rp_5
    v_lshlrev_b32 v17, 2, v169
    v_lshlrev_b32 v18, 1, v169
    s_mov_b64 exec, vcc
    ds_write_b32 v17, v77 offset:0
    ds_write_b16 v18, v67 offset:9216
    ds_write_b16_d16_hi v18, v67 offset:13824
    s_mov_b64 exec, -1
L_pl_rp_5:
    v_sub_u32 v17, v78, v238
    v_subrev_u32 v17, 10240, v17
    v_sub_u32 v17, v17, v230
    v_add_u32 v170, v17, v170
    v_mad_i32_i24 v17, v178, s68, v170
    v_cmp_gt_u32 vcc, s69, v17
    s_cbranch_vccz L_pl_rp_6
    v_lshlrev_b32 v17, 2, v170
    v_lshlrev_b32 v18, 1, v170
    s_mov_b64 exec, vcc
    ds_write_b32 v17, v78 offset:0
    ds_write_b16 v18, v69 offset:9216
    ds_write_b16_d16_hi v18, v69 offset:13824
    s_mov_b64 exec, -1
L_pl_rp_6:
    v_sub_u32 v17, v79, v238
    v_subrev_u32 v17, 15360, v17
    v_sub_u32 v17, v17, v231
    v_add_u32 v171, v17, v171
    v_mad_i32_i24 v17, v179, s68, v171
    v_cmp_gt_u32 vcc, s69, v17
    s_cbranch_vccz L_pl_rp_7
    v_lshlrev_b32 v17, 2, v171
    v_lshlrev_b32 v18, 1, v171
    s_mov_b64 exec, vcc
    ds_write_b32 v17, v79 offset:0
    ds_write_b16 v18, v71 offset:9216
    ds_write_b16_d16_hi v18, v71 offset:13824
    s_mov_b64 exec, -1
L_pl_rp_7:
    s_mov_b32 s15, 10240000
    v_add3_u32 v188, v228, v192, 32
    v_add3_u32 v189, v229, v192, 32
    v_add3_u32 v190, v230, v192, 32
    v_add3_u32 v191, v231, v192, 32
L_more_r:
    v_cmp_lt_u32 s[12:13], v188, v232
    v_cmp_lt_u32 vcc, v189, v233
    s_nop 0
    s_or_b64 s[12:13], s[12:13], vcc
    v_cmp_lt_u32 vcc, v190, v234
    s_nop 0
    s_or_b64 s[12:13], s[12:13], vcc
    v_cmp_lt_u32 vcc, v191, v235
    s_nop 0
    s_or_b64 s[12:13], s[12:13], vcc
    s_cmp_eq_u64 s[12:13], 0
    s_cbranch_scc1 L_done_r
    v_cmp_lt_u32 vcc, v188, v232
    v_add_u32 v72, v188, v238
    s_nop 0
    v_cndmask_b32 v72, v193, v72, vcc
    v_lshlrev_b32 v18, 2, v72
    buffer_load_dword v64, v18, s[52:55], s15 offen
    v_cmp_lt_u32 vcc, v189, v233
    v_add_u32 v73, v189, v238
    v_add_u32 v73, 5120, v73
    v_cndmask_b32 v73, v193, v73, vcc
    v_lshlrev_b32 v18, 2, v73
    buffer_load_dword v66, v18, s[52:55], s15 offen
    v_cmp_lt_u32 vcc, v190, v234
    v_add_u32 v74, v190, v238
    v_add_u32 v74, 10240, v74
    v_cndmask_b32 v74, v193, v74, vcc
    v_lshlrev_b32 v18, 2, v74
    buffer_load_dword v68, v18, s[52:55], s15 offen
    v_cmp_lt_u32 vcc, v191, v235
    v_add_u32 v75, v191, v238
    v_add_u32 v75, 15360, v75
    v_cndmask_b32 v75, v193, v75, vcc
    v_lshlrev_b32 v18, 2, v75
    buffer_load_dword v70, v18, s[52:55], s15 offen
    v_add_u32 v17, 16, v188
    v_cmp_lt_u32 vcc, v17, v232
    v_add_u32 v76, v17, v238
    s_nop 0
    v_cndmask_b32 v76, v193, v76, vcc
    v_lshlrev_b32 v18, 2, v76
    buffer_load_dword v65, v18, s[52:55], s15 offen
    v_add_u32 v17, 16, v189
    v_cmp_lt_u32 vcc, v17, v233
    v_add_u32 v77, v17, v238
    v_add_u32 v77, 5120, v77
    v_cndmask_b32 v77, v193, v77, vcc
    v_lshlrev_b32 v18, 2, v77
    buffer_load_dword v67, v18, s[52:55], s15 offen
    v_add_u32 v17, 16, v190
    v_cmp_lt_u32 vcc, v17, v234
    v_add_u32 v78, v17, v238
    v_add_u32 v78, 10240, v78
    v_cndmask_b32 v78, v193, v78, vcc
    v_lshlrev_b32 v18, 2, v78
    buffer_load_dword v69, v18, s[52:55], s15 offen
    v_add_u32 v17, 16, v191
    v_cmp_lt_u32 vcc, v17, v235
    v_add_u32 v79, v17, v238
    v_add_u32 v79, 15360, v79
    v_cndmask_b32 v79, v193, v79, vcc
    v_lshlrev_b32 v18, 2, v79
    buffer_load_dword v71, v18, s[52:55], s15 offen
    s_waitcnt vmcnt(0)
    v_bfe_u32 v172, v64, 22, 2
    v_lshl_add_u32 v17, v172, 2, v239
    ds_read_b32 v164, v17 offset:18432
    v_bfe_u32 v173, v66, 22, 2
    v_lshl_add_u32 v17, v173, 2, v239
    ds_read_b32 v165, v17 offset:18496
    v_bfe_u32 v174, v68, 22, 2
    v_lshl_add_u32 v17, v174, 2, v239
    ds_read_b32 v166, v17 offset:18560
    v_bfe_u32 v175, v70, 22, 2
    v_lshl_add_u32 v17, v175, 2, v239
    ds_read_b32 v167, v17 offset:18624
    v_bfe_u32 v176, v65, 22, 2
    v_lshl_add_u32 v17, v176, 2, v239
    ds_read_b32 v168, v17 offset:18432
    v_bfe_u32 v177, v67, 22, 2
    v_lshl_add_u32 v17, v177, 2, v239
    ds_read_b32 v169, v17 offset:18496
    v_bfe_u32 v178, v69, 22, 2
    v_lshl_add_u32 v17, v178, 2, v239
    ds_read_b32 v170, v17 offset:18560
    v_bfe_u32 v179, v71, 22, 2
    v_lshl_add_u32 v17, v179, 2, v239
    ds_read_b32 v171, v17 offset:18624
    s_waitcnt lgkmcnt(0)
    v_sub_u32 v17, v72, v238
    v_sub_u32 v17, v17, v228
    v_add_u32 v164, v17, v164
    v_mad_i32_i24 v17, v172, s68, v164
    v_cmp_gt_u32 vcc, s69, v17
    s_cbranch_vccz L_pl_r_0
    v_lshlrev_b32 v17, 2, v164
    v_lshlrev_b32 v18, 1, v164
    s_mov_b64 exec, vcc
    ds_write_b32 v17, v72 offset:0
    ds_write_b16 v18, v64 offset:9216
    ds_write_b16_d16_hi v18, v64 offset:13824
    s_mov_b64 exec, -1
L_pl_r_0:
    v_sub_u32 v17, v73, v238
    v_subrev_u32 v17, 5120, v17
    v_sub_u32 v17, v17, v229
    v_add_u32 v165, v17, v165
    v_mad_i32_i24 v17, v173, s68, v165
    v_cmp_gt_u32 vcc, s69, v17
    s_cbranch_vccz L_pl_r_1
    v_lshlrev_b32 v17, 2, v165
    v_lshlrev_b32 v18, 1, v165
    s_mov_b64 exec, vcc
    ds_write_b32 v17, v73 offset:0
    ds_write_b16 v18, v66 offset:9216
    ds_write_b16_d16_hi v18, v66 offset:13824
    s_mov_b64 exec, -1
L_pl_r_1:
    v_sub_u32 v17, v74, v238
    v_subrev_u32 v17, 10240, v17
    v_sub_u32 v17, v17, v230
    v_add_u32 v166, v17, v166
    v_mad_i32_i24 v17, v174, s68, v166
    v_cmp_gt_u32 vcc, s69, v17
    s_cbranch_vccz L_pl_r_2
    v_lshlrev_b32 v17, 2, v166
    v_lshlrev_b32 v18, 1, v166
    s_mov_b64 exec, vcc
    ds_write_b32 v17, v74 offset:0
    ds_write_b16 v18, v68 offset:9216
    ds_write_b16_d16_hi v18, v68 offset:13824
    s_mov_b64 exec, -1
L_pl_r_2:
    v_sub_u32 v17, v75, v238
    v_subrev_u32 v17, 15360, v17
    v_sub_u32 v17, v17, v231
    v_add_u32 v167, v17, v167
    v_mad_i32_i24 v17, v175, s68, v167
    v_cmp_gt_u32 vcc, s69, v17
    s_cbranch_vccz L_pl_r_3
    v_lshlrev_b32 v17, 2, v167
    v_lshlrev_b32 v18, 1, v167
    s_mov_b64 exec, vcc
    ds_write_b32 v17, v75 offset:0
    ds_write_b16 v18, v70 offset:9216
    ds_write_b16_d16_hi v18, v70 offset:13824
    s_mov_b64 exec, -1
L_pl_r_3:
    v_sub_u32 v17, v76, v238
    v_sub_u32 v17, v17, v228
    v_add_u32 v168, v17, v168
    v_mad_i32_i24 v17, v176, s68, v168
    v_cmp_gt_u32 vcc, s69, v17
    s_cbranch_vccz L_pl_r_4
    v_lshlrev_b32 v17, 2, v168
    v_lshlrev_b32 v18, 1, v168
    s_mov_b64 exec, vcc
    ds_write_b32 v17, v76 offset:0
    ds_write_b16 v18, v65 offset:9216
    ds_write_b16_d16_hi v18, v65 offset:13824
    s_mov_b64 exec, -1
L_pl_r_4:
    v_sub_u32 v17, v77, v238
    v_subrev_u32 v17, 5120, v17
    v_sub_u32 v17, v17, v229
    v_add_u32 v169, v17, v169
    v_mad_i32_i24 v17, v177, s68, v169
    v_cmp_gt_u32 vcc, s69, v17
    s_cbranch_vccz L_pl_r_5
    v_lshlrev_b32 v17, 2, v169
    v_lshlrev_b32 v18, 1, v169
    s_mov_b64 exec, vcc
    ds_write_b32 v17, v77 offset:0
    ds_write_b16 v18, v67 offset:9216
    ds_write_b16_d16_hi v18, v67 offset:13824
    s_mov_b64 exec, -1
L_pl_r_5:
    v_sub_u32 v17, v78, v238
    v_subrev_u32 v17, 10240, v17
    v_sub_u32 v17, v17, v230
    v_add_u32 v170, v17, v170
    v_mad_i32_i24 v17, v178, s68, v170
    v_cmp_gt_u32 vcc, s69, v17
    s_cbranch_vccz L_pl_r_6
    v_lshlrev_b32 v17, 2, v170
    v_lshlrev_b32 v18, 1, v170
    s_mov_b64 exec, vcc
    ds_write_b32 v17, v78 offset:0
    ds_write_b16 v18, v69 offset:9216
    ds_write_b16_d16_hi v18, v69 offset:13824
    s_mov_b64 exec, -1
L_pl_r_6:
    v_sub_u32 v17, v79, v238
    v_subrev_u32 v17, 15360, v17
    v_sub_u32 v17, v17, v231
    v_add_u32 v171, v17, v171
    v_mad_i32_i24 v17, v179, s68, v171
    v_cmp_gt_u32 vcc, s69, v17
    s_cbranch_vccz L_pl_r_7
    v_lshlrev_b32 v17, 2, v171
    v_lshlrev_b32 v18, 1, v171
    s_mov_b64 exec, vcc
    ds_write_b32 v17, v79 offset:0
    ds_write_b16 v18, v71 offset:9216
    ds_write_b16_d16_hi v18, v71 offset:13824
    s_mov_b64 exec, -1
L_pl_r_7:
    v_add_u32 v188, 32, v188
    v_add_u32 v189, 32, v189
    v_add_u32 v190, 32, v190
    v_add_u32 v191, 32, v191
    s_branch L_more_r
L_done_r:
    s_waitcnt lgkmcnt(0)
    s_barrier
    s_mul_i32 s11, s62, 416
    s_sub_i32 s11, s61, s11
    s_max_i32 s11, s11, 0
    s_min_i32 s11, s11, 416
    s_add_u32 s11, s11, 31
    s_lshr_b32 s60, s11, 5
    s_mul_i32 s11, s6, 576
    v_lshrrev_b32 v17, 3, v1
    v_add_lshl_u32 v4, v17, s11, 1
    v_add_lshl_u32 v5, v2, s11, 2
    v_lshrrev_b32 v6, 1, v5
    s_branch L_pipe
L_k2_exit:
    s_endpgm
.section .rodata,"a"
.p2align 6
.amdhsa_kernel gcn_prep_kernel
  .amdhsa_next_free_vgpr 128
  .amdhsa_next_free_sgpr 80
  .amdhsa_accum_offset 128
  .amdhsa_group_segment_fixed_size 0
  .amdhsa_kernarg_size 96
  .amdhsa_user_sgpr_count 2
  .amdhsa_user_sgpr_kernarg_segment_ptr 1
  .amdhsa_system_sgpr_workgroup_id_x 1
.end_amdhsa_kernel
.p2align 6
.amdhsa_kernel gcn_edge_kernel
  .amdhsa_next_free_vgpr 255
  .amdhsa_next_free_sgpr 96
  .amdhsa_accum_offset 256
  .amdhsa_group_segment_fixed_size 0
  .amdhsa_kernarg_size 96
  .amdhsa_user_sgpr_count 2
  .amdhsa_user_sgpr_kernarg_segment_ptr 1
  .amdhsa_system_sgpr_workgroup_id_x 1
.end_amdhsa_kernel
```
